```python
import torch

def _softmax(x, axis=-1):
    return torch.softmax(x, dim=axis)
def _gelu(x):
    return torch.nn.functional.gelu(x, approximate="tanh")
def _silu(x):
    return torch.nn.functional.silu(x)
def _sigmoid(x):
    return torch.sigmoid(x)
def _layernorm(x, axis=-1, eps=1e-5):
    m = x.mean(dim=axis, keepdim=True)
    v = x.var(dim=axis, keepdim=True, unbiased=False)
    return (x - m) / torch.sqrt(v + eps)
def _scatter_add(tgt, idx, src, axis=0):
    return tgt.clone().index_add_(axis, idx, src)
def _segment_sum(src, seg, n):
    out = torch.zeros((n,) + src.shape[1:], dtype=src.dtype)
    return out.index_add_(0, seg, src)
def _pad(x, pw):
    flat = tuple(v for pair in reversed(pw) for v in pair)
    return torch.nn.functional.pad(x, flat)

kernel_name = 'gated_mix__linear_attn_block__dense_activation_squared_relu__prompt'

def setup_inputs():

    _w = (lambda a: (lambda t: t.to(torch.bfloat16) if t.is_floating_point() else t)(torch.as_tensor(a)))
    def _A_setup():
        B, S, D = 1, 2048, 448
        return {
            "x": _w((lambda *s: torch.randn(*s, dtype=torch.bfloat16) * 0.05)(B, S, D)),
            "wqkv": _w((lambda *s: torch.randn(*s, dtype=torch.bfloat16) * 0.8)(D, 3 * D)),
            "wo": _w((lambda *s: torch.randn(*s, dtype=torch.bfloat16) * 0.2)(D, D)),
        }
    _A_in = _A_setup()

    def _B_setup():
        B, S, D, F = 1, 2048, 448, 1792
        return {
            "x": _w((lambda *s: torch.randn(*s, dtype=torch.bfloat16) * 0.05)(B, S, D)),
            "w1": _w((lambda *s: torch.randn(*s, dtype=torch.bfloat16) * 0.05)(D, F)),
            "b1": _w((lambda *s: torch.randn(*s, dtype=torch.bfloat16) * 0.05)(F)),
            "w2": _w((lambda *s: torch.randn(*s, dtype=torch.bfloat16) * 0.05)(F, D)),
            "b2": _w((lambda *s: torch.randn(*s, dtype=torch.bfloat16) * 0.05)(D)),
        }
    _B_in = _B_setup()

    return {
        "A_x": _A_in["x"],
        "A_wqkv": _A_in["wqkv"],
        "A_wo": _A_in["wo"],
        "B_x": _B_in["x"],
        "B_w1": _B_in["w1"],
        "B_b1": _B_in["b1"],
        "B_w2": _B_in["w2"],
        "B_b2": _B_in["b2"],
        "gate_w": _w((lambda *s: torch.randn(*s, dtype=torch.bfloat16) * 0.05)(448) * 16.0),
    }

def reference(A_x, A_wqkv, A_wo, B_x, B_w1, B_b1, B_w2, B_b2, gate_w):
    def _A_ref(x, wqkv, wo):
        B, S, D = x.shape
        H = 16; Dh = D // H
        qkv = (lambda x, *d: x.permute(*d))((x @ wqkv).reshape(B, S, 3, H, Dh), 2, 0, 3, 1, 4)
        q, k, v = qkv[0], qkv[1], qkv[2]
        phi = lambda t: torch.where(t > 0, t + 1, torch.exp(t)) + 1e-6
        pq, pk = phi(q), phi(k)
        kv = torch.einsum("bhsd,bhse->bhde", pk, v)
        z = torch.einsum("bhsd->bhd", pk)
        num = torch.einsum("bhqd,bhde->bhqe", pq, kv)
        den = torch.einsum("bhqd,bhd->bhq", pq, z)[..., None] + 1e-6
        o = num / den
        return (lambda x, *d: x.permute(*d))(o, 0, 2, 1, 3).reshape(B, S, D) @ wo

    def _B_ref(x, w1, b1, w2, b2):
        h = torch.einsum("bsd,df->bsf", x, w1) + b1
        zero = torch.zeros_like(h)
        r = torch.where(h > zero, h, zero)
        h = r * r
        out = torch.einsum("bsf,fd->bsd", h, w2) + b2
        return out

    x = A_x
    g = _sigmoid((x * gate_w).sum(-1, keepdims=True))
    a = _A_ref(x, A_wqkv, A_wo)
    b = _B_ref(x, B_w1, B_b1, B_w2, B_b2)
    return g * a + (1 - g) * b
```

```asm
; @launch grid=(256,1,1) block=(512,1,1) lds=163840
.amdgcn_target "amdgcn-amd-amdhsa--gfx950"
.text
.globl gated_mix__linear_attn_block__dense_activation_squared_relu__prompt_kernel
.p2align 8
.type gated_mix__linear_attn_block__dense_activation_squared_relu__prompt_kernel,@function
gated_mix__linear_attn_block__dense_activation_squared_relu__prompt_kernel:
  s_cmp_ge_u32 s2, 256
  s_cbranch_scc1 L_end
  s_load_dwordx16 s[4:19], s[0:1], 0
  s_load_dwordx8 s[20:27], s[0:1], 64
  s_getpc_b64 s[86:87]
L_pc:
  v_lshrrev_b32 v7, 6, v0
  s_lshr_b32 s35, s2, 3
  s_lshl_b32 s35, s35, 3
  v_add_u32 v7, s35, v7
  v_and_b32 v8, 63, v0
  v_min_u32 v8, 1, v8
  v_lshl_add_u32 v7, v7, 1, v8
  v_lshlrev_b32 v7, 7, v7
  v_min_u32 v7, L_end-L_pc, v7
  global_load_dword v239, v7, s[86:87]
  v_and_b32 v1, 63, v0
  v_lshrrev_b32 v2, 6, v0
  s_nop 0
  v_readfirstlane_b32 s28, v2
  s_and_b32 s33, s2, 7
  s_lshr_b32 s34, s2, 3
  s_and_b32 s30, s33, 1
  s_lshl_b32 s30, s30, 3
  s_and_b32 s35, s34, 7
  s_add_u32 s30, s30, s35
  s_bfe_u32 s31, s33, 0x10001
  s_lshl_b32 s31, s31, 2
  s_lshr_b32 s35, s34, 3
  s_add_u32 s31, s31, s35
  s_lshr_b32 s75, s33, 2
  s_and_b32 s29, s28, 3
  v_and_b32 v2, 31, v1
  v_lshrrev_b32 v3, 5, v1
  v_bfe_u32 v4, v1, 4, 1
  v_bfe_u32 v5, v1, 2, 2
  v_and_b32 v6, 3, v1
  s_cmp_eq_u32 s75, 1
  s_mov_b32 s77, 2688
  s_cselect_b32 s77, 3584, s77
  s_waitcnt lgkmcnt(0)
  s_mov_b32 s36, s4
  s_and_b32 s37, s5, 0xffff
  s_mov_b32 s38, 1835008
  s_mov_b32 s39, 0x20000
  s_cmp_eq_u32 s75, 1
  s_cselect_b32 s40, s12, s6
  s_cselect_b32 s41, s13, s7
  s_mov_b32 s42, 1204224
  s_cselect_b32 s42, 1605632, s42
  s_and_b32 s41, s41, 0xffff
  s_mov_b32 s43, 0x20000
  s_mov_b32 s44, s26
  s_and_b32 s45, s27, 0xffff
  s_mov_b32 s46, 268435456
  s_mov_b32 s47, 0x20000
  s_load_dword s74, s[26:27], 8192
  s_cmp_ge_u32 s28, 4
  s_cbranch_scc1 L_loader
  s_cmp_lt_u32 s33, 2
  s_cselect_b32 s91, 24, 28
  s_sub_u32 s35, s34, s91
  s_cmp_lt_u32 s35, 4
  s_cselect_b32 s76, 1, 0
  s_cmp_gt_u32 s34, s91
  s_cselect_b32 s35, 4, 0
  s_sub_u32 s35, s34, s35
  s_min_u32 s35, s35, 27
  s_mul_i32 s91, s33, 28
  s_add_u32 s91, s91, s35
  s_mul_i32 s35, s91, 293
  s_lshr_b32 s72, s35, 11
  s_mul_i32 s35, s72, 7
  s_sub_u32 s73, s91, s35
  v_mov_b32 v249, 0
  v_lshlrev_b32 v18, 3, v1
  s_mov_b32 s52, s18
  s_and_b32 s53, s19, 0xffff
  s_mov_b32 s54, 896
  s_mov_b32 s55, 0x20000
  s_lshl_b32 s68, s73, 7
  buffer_load_dwordx2 v[224:225], v18, s[52:55], s68 offen
  s_cmp_eq_u32 s75, 0
  s_cbranch_scc1 Lnb_1
  s_mov_b32 s48, s14
  s_and_b32 s49, s15, 0xffff
  s_mov_b32 s50, 3584
  s_mov_b32 s51, 0x20000
  s_mul_i32 s62, s31, 224
  s_mov_b32 s63, s62
  s_bitcmp1_b32 s31, 0
  s_cselect_b32 s35, 0, 128
  s_add_u32 s62, s62, s35
  s_bitcmp1_b32 s31, 0
  s_cselect_b32 s35, 96, 0
  s_add_u32 s63, s63, s35
  s_mul_i32 s68, s31, 448
  buffer_load_dwordx2 v[184:185], v18, s[48:51], s68 offen
  s_branch Lnz_2
Lnb_1:
  s_cmp_lg_u32 s30, 0
  s_cbranch_scc1 Lnz_2
  v_mov_b32 v8, 0
  v_mov_b32 v9, 0
  v_mov_b32 v10, 0
  v_mov_b32 v11, 0
  v_lshlrev_b32 v7, 4, v1
  s_lshl_b32 s35, s31, 13
  s_lshl_b32 s68, s29, 11
  s_add_u32 s35, s35, s68
  s_add_u32 s35, s35, 65536
  buffer_store_dwordx4 v[8:11], v7, s[44:47], s35 offen sc1
  buffer_store_dwordx4 v[8:11], v7, s[44:47], s35 offen offset:1024 sc1
  s_nop 1
Lnz_2:
  s_and_b32 s35, s33, 3
  s_lshl_b32 s35, s35, 5
  s_add_u32 s93, s35, s34
  s_mov_b32 s52, s16
  s_and_b32 s53, s17, 0xffff
  s_mov_b32 s54, 1605632
  s_mov_b32 s55, 0x20000
  s_mul_i32 s94, s93, 98
  s_mul_i32 s35, s29, 49
  s_add_u32 s94, s94, s35
  s_lshl_b32 s94, s94, 7
  v_mov_b32 v7, 49
  s_cmp_lt_u32 s29, 2
  s_cbranch_scc1 Lpm_3
  s_mov_b32 s52, s8
  s_and_b32 s53, s9, 0xffff
  s_mov_b32 s54, 401408
  s_mov_b32 s55, 0x20000
  s_mul_i32 s94, s93, 3200
  v_mov_b32 v7, 25
  s_cmp_eq_u32 s29, 2
  s_cbranch_scc1 Lpm_3
  v_mov_b32 v7, 0
Lpm_3:
  v_cmp_gt_u32 vcc, v7, v1
  v_lshlrev_b32 v8, 7, v1
  v_or_b32 v9, 0x40000000, v8
  v_cndmask_b32 v248, v9, v8, vcc
  s_cmp_eq_u32 s75, 0
  s_cbranch_scc1 L_consA
  s_branch L_consF
L_loader:
  v_lshrrev_b32 v7, 3, v1
  v_mul_u32_u24 v7, 896, v7
  s_and_b32 s35, s29, 1
  s_lshl_b32 s35, s35, 2
  v_lshrrev_b32 v8, 4, v1
  v_or_b32 v9, s35, v8
  v_and_b32 v13, 7, v1
  v_xor_b32 v9, v9, v13
  v_lshl_add_u32 v10, v9, 4, v7
  s_lshl_b32 s60, s30, 4
  s_add_u32 s60, s60, s29
  s_mul_i32 s60, s60, 7168
  s_lshl_b32 s63, s29, 10
  s_add_u32 s83, s30, s31
  s_and_b32 s83, s83, 1
  s_mul_i32 s83, s83, 3
  s_mov_b32 s84, s83
  s_lshl_b32 s67, s83, 7
  s_add_u32 s67, s67, s60
  s_add_u32 m0, s63, 0
  s_add_u32 s64, s67, 0
  buffer_load_dwordx4 v10, s[36:39], s64 offen lds
  s_add_u32 m0, s63, 4096
  s_add_u32 s64, s67, 28672
  buffer_load_dwordx4 v10, s[36:39], s64 offen lds
  s_add_u32 m0, s63, 8192
  s_add_u32 s64, s67, 57344
  buffer_load_dwordx4 v10, s[36:39], s64 offen lds
  s_add_u32 m0, s63, 12288
  s_add_u32 s64, s67, 86016
  buffer_load_dwordx4 v10, s[36:39], s64 offen lds
  s_add_u32 s83, s83, 1
  s_cmp_eq_u32 s83, 7
  s_cselect_b32 s83, 0, s83
  v_and_b32 v13, 15, v1
  v_lshlrev_b32 v9, 2, v8
  v_xor_b32 v13, v13, v9
  v_mul_lo_u32 v7, v8, s77
  s_cmp_eq_u32 s75, 1
  s_mov_b32 s78, 896
  s_cselect_b32 s78, 128, s78
  s_cselect_b32 s79, 12, 16
  v_and_b32 v9, 7, v13
  v_lshl_add_u32 v7, v9, 4, v7
  v_lshrrev_b32 v9, 3, v13
  v_mul_lo_u32 v9, v9, s78
  v_add_u32 v12, v7, v9
  v_or_b32 v7, 0x40000000, v12
  v_cmp_gt_u32 vcc, s79, v13
  s_nop 1
  v_cndmask_b32 v11, v7, v12, vcc
  s_mul_i32 s61, s31, 448
  s_mov_b32 s62, s61
  s_bitcmp1_b32 s31, 0
  s_cselect_b32 s35, 0, 256
  s_add_u32 s61, s61, s35
  s_bitcmp1_b32 s31, 0
  s_cselect_b32 s35, 192, 0
  s_add_u32 s62, s62, s35
  s_mul_i32 s35, s31, 112
  s_add_u32 s35, s35, 896
  s_cmp_eq_u32 s75, 1
  s_cselect_b32 s61, s61, s35
  s_lshl_b32 s65, s77, 4
  s_lshl_b32 s66, s77, 6
  s_mul_i32 s35, s29, s77
  s_lshl_b32 s35, s35, 2
  s_add_u32 s61, s61, s35
  s_add_u32 s62, s62, s35
  s_mul_i32 s64, s84, s66
  s_add_u32 s64, s64, s61
  s_add_u32 m0, s63, 114688
  s_nop 0
  buffer_load_dwordx4 v11, s[40:43], s64 offen lds
  s_add_u32 m0, s63, 118784
  s_add_u32 s64, s64, s65
  buffer_load_dwordx4 v11, s[40:43], s64 offen lds
  s_add_u32 m0, s63, 122880
  s_add_u32 s64, s64, s65
  buffer_load_dwordx4 v11, s[40:43], s64 offen lds
  s_add_u32 m0, s63, 126976
  s_add_u32 s64, s64, s65
  buffer_load_dwordx4 v11, s[40:43], s64 offen lds
  s_add_u32 s84, s84, 1
  s_cmp_eq_u32 s84, 7
  s_cselect_b32 s84, 0, s84
  s_lshl_b32 s67, s83, 7
  s_add_u32 s67, s67, s60
  s_add_u32 m0, s63, 16384
  s_add_u32 s64, s67, 0
  buffer_load_dwordx4 v10, s[36:39], s64 offen lds
  s_add_u32 m0, s63, 20480
  s_add_u32 s64, s67, 28672
  buffer_load_dwordx4 v10, s[36:39], s64 offen lds
  s_add_u32 m0, s63, 24576
  s_add_u32 s64, s67, 57344
  buffer_load_dwordx4 v10, s[36:39], s64 offen lds
  s_add_u32 m0, s63, 28672
  s_add_u32 s64, s67, 86016
  buffer_load_dwordx4 v10, s[36:39], s64 offen lds
  s_add_u32 s83, s83, 1
  s_cmp_eq_u32 s83, 7
  s_cselect_b32 s83, 0, s83
  s_mul_i32 s64, s84, s66
  s_add_u32 s64, s64, s61
  s_add_u32 m0, s63, 131072
  s_nop 0
  buffer_load_dwordx4 v11, s[40:43], s64 offen lds
  s_add_u32 m0, s63, 135168
  s_add_u32 s64, s64, s65
  buffer_load_dwordx4 v11, s[40:43], s64 offen lds
  s_add_u32 m0, s63, 139264
  s_add_u32 s64, s64, s65
  buffer_load_dwordx4 v11, s[40:43], s64 offen lds
  s_add_u32 m0, s63, 143360
  s_add_u32 s64, s64, s65
  buffer_load_dwordx4 v11, s[40:43], s64 offen lds
  s_add_u32 s84, s84, 1
  s_cmp_eq_u32 s84, 7
  s_cselect_b32 s84, 0, s84
  s_mov_b32 s48, s20
  s_and_b32 s49, s21, 0xffff
  s_mov_b32 s50, 896
  s_mov_b32 s51, 0x20000
  v_and_b32 v13, 7, v1
  v_lshlrev_b32 v19, 4, v13
  v_lshrrev_b32 v7, 3, v1
  v_mul_u32_u24 v7, 2688, v7
  v_and_b32 v9, 1, v8
  v_lshlrev_b32 v9, 2, v9
  v_xor_b32 v9, v9, v13
  v_lshl_add_u32 v13, v9, 4, v7
  s_mul_i32 s82, s31, 112
  s_mul_i32 s35, s29, 43008
  s_add_u32 s82, s82, s35
  s_cmp_lt_u32 s33, 2
  s_cselect_b32 s91, 24, 28
  s_sub_u32 s35, s34, s91
  s_cmp_lt_u32 s35, 4
  s_cselect_b32 s76, 1, 0
  s_cmp_gt_u32 s34, s91
  s_cselect_b32 s35, 4, 0
  s_sub_u32 s35, s34, s35
  s_min_u32 s35, s35, 27
  s_mul_i32 s91, s33, 28
  s_add_u32 s91, s91, s35
  s_mul_i32 s35, s91, 293
  s_lshr_b32 s72, s35, 11
  s_mul_i32 s35, s72, 7
  s_sub_u32 s73, s91, s35
  s_waitcnt vmcnt(8)
  s_barrier
  s_lshl_b32 s67, s83, 7
  s_add_u32 s67, s67, s60
  s_add_u32 m0, s63, 32768
  s_add_u32 s64, s67, 0
  buffer_load_dwordx4 v10, s[36:39], s64 offen lds
  s_add_u32 m0, s63, 36864
  s_add_u32 s64, s67, 28672
  buffer_load_dwordx4 v10, s[36:39], s64 offen lds
  s_add_u32 m0, s63, 40960
  s_add_u32 s64, s67, 57344
  buffer_load_dwordx4 v10, s[36:39], s64 offen lds
  s_add_u32 m0, s63, 45056
  s_add_u32 s64, s67, 86016
  buffer_load_dwordx4 v10, s[36:39], s64 offen lds
  s_add_u32 s83, s83, 1
  s_cmp_eq_u32 s83, 7
  s_cselect_b32 s83, 0, s83
  s_mul_i32 s64, s84, s66
  s_add_u32 s64, s64, s61
  s_add_u32 m0, s63, 147456
  s_nop 0
  buffer_load_dwordx4 v11, s[40:43], s64 offen lds
  s_add_u32 m0, s63, 151552
  s_add_u32 s64, s64, s65
  buffer_load_dwordx4 v11, s[40:43], s64 offen lds
  s_add_u32 m0, s63, 155648
  s_add_u32 s64, s64, s65
  buffer_load_dwordx4 v11, s[40:43], s64 offen lds
  s_add_u32 m0, s63, 159744
  s_add_u32 s64, s64, s65
  buffer_load_dwordx4 v11, s[40:43], s64 offen lds
  s_add_u32 s84, s84, 1
  s_cmp_eq_u32 s84, 7
  s_cselect_b32 s84, 0, s84
  s_waitcnt vmcnt(8)
  s_barrier
  s_lshl_b32 s67, s83, 7
  s_add_u32 s67, s67, s60
  s_add_u32 m0, s63, 49152
  s_add_u32 s64, s67, 0
  buffer_load_dwordx4 v10, s[36:39], s64 offen lds
  s_add_u32 m0, s63, 53248
  s_add_u32 s64, s67, 28672
  buffer_load_dwordx4 v10, s[36:39], s64 offen lds
  s_add_u32 m0, s63, 57344
  s_add_u32 s64, s67, 57344
  buffer_load_dwordx4 v10, s[36:39], s64 offen lds
  s_add_u32 m0, s63, 61440
  s_add_u32 s64, s67, 86016
  buffer_load_dwordx4 v10, s[36:39], s64 offen lds
  s_add_u32 s83, s83, 1
  s_cmp_eq_u32 s83, 7
  s_cselect_b32 s83, 0, s83
  s_mul_i32 s64, s84, s66
  s_add_u32 s64, s64, s61
  s_add_u32 m0, s63, 114688
  s_nop 0
  buffer_load_dwordx4 v11, s[40:43], s64 offen lds
  s_add_u32 m0, s63, 118784
  s_add_u32 s64, s64, s65
  buffer_load_dwordx4 v11, s[40:43], s64 offen lds
  s_add_u32 m0, s63, 122880
  s_add_u32 s64, s64, s65
  buffer_load_dwordx4 v11, s[40:43], s64 offen lds
  s_add_u32 m0, s63, 126976
  s_add_u32 s64, s64, s65
  buffer_load_dwordx4 v11, s[40:43], s64 offen lds
  s_add_u32 s84, s84, 1
  s_cmp_eq_u32 s84, 7
  s_cselect_b32 s84, 0, s84
  s_waitcnt vmcnt(8)
  s_barrier
  s_lshl_b32 s67, s83, 7
  s_add_u32 s67, s67, s60
  s_add_u32 m0, s63, 65536
  s_add_u32 s64, s67, 0
  buffer_load_dwordx4 v10, s[36:39], s64 offen lds
  s_add_u32 m0, s63, 69632
  s_add_u32 s64, s67, 28672
  buffer_load_dwordx4 v10, s[36:39], s64 offen lds
  s_add_u32 m0, s63, 73728
  s_add_u32 s64, s67, 57344
  buffer_load_dwordx4 v10, s[36:39], s64 offen lds
  s_add_u32 m0, s63, 77824
  s_add_u32 s64, s67, 86016
  buffer_load_dwordx4 v10, s[36:39], s64 offen lds
  s_add_u32 s83, s83, 1
  s_cmp_eq_u32 s83, 7
  s_cselect_b32 s83, 0, s83
  s_mul_i32 s64, s84, s66
  s_add_u32 s64, s64, s61
  s_add_u32 m0, s63, 131072
  s_nop 0
  buffer_load_dwordx4 v11, s[40:43], s64 offen lds
  s_add_u32 m0, s63, 135168
  s_add_u32 s64, s64, s65
  buffer_load_dwordx4 v11, s[40:43], s64 offen lds
  s_add_u32 m0, s63, 139264
  s_add_u32 s64, s64, s65
  buffer_load_dwordx4 v11, s[40:43], s64 offen lds
  s_add_u32 m0, s63, 143360
  s_add_u32 s64, s64, s65
  buffer_load_dwordx4 v11, s[40:43], s64 offen lds
  s_add_u32 s84, s84, 1
  s_cmp_eq_u32 s84, 7
  s_cselect_b32 s84, 0, s84
  s_waitcnt vmcnt(8)
  s_barrier
  s_lshl_b32 s67, s83, 7
  s_add_u32 s67, s67, s60
  s_add_u32 m0, s63, 81920
  s_add_u32 s64, s67, 0
  buffer_load_dwordx4 v10, s[36:39], s64 offen lds
  s_add_u32 m0, s63, 86016
  s_add_u32 s64, s67, 28672
  buffer_load_dwordx4 v10, s[36:39], s64 offen lds
  s_add_u32 m0, s63, 90112
  s_add_u32 s64, s67, 57344
  buffer_load_dwordx4 v10, s[36:39], s64 offen lds
  s_add_u32 m0, s63, 94208
  s_add_u32 s64, s67, 86016
  buffer_load_dwordx4 v10, s[36:39], s64 offen lds
  s_add_u32 s83, s83, 1
  s_cmp_eq_u32 s83, 7
  s_cselect_b32 s83, 0, s83
  s_mul_i32 s64, s84, s66
  s_add_u32 s64, s64, s61
  s_add_u32 m0, s63, 147456
  s_nop 0
  buffer_load_dwordx4 v11, s[40:43], s64 offen lds
  s_add_u32 m0, s63, 151552
  s_add_u32 s64, s64, s65
  buffer_load_dwordx4 v11, s[40:43], s64 offen lds
  s_add_u32 m0, s63, 155648
  s_add_u32 s64, s64, s65
  buffer_load_dwordx4 v11, s[40:43], s64 offen lds
  s_add_u32 m0, s63, 159744
  s_add_u32 s64, s64, s65
  buffer_load_dwordx4 v11, s[40:43], s64 offen lds
  s_add_u32 s84, s84, 1
  s_cmp_eq_u32 s84, 7
  s_cselect_b32 s84, 0, s84
  s_waitcnt vmcnt(8)
  s_barrier
  s_lshl_b32 s67, s83, 7
  s_add_u32 s67, s67, s60
  s_add_u32 m0, s63, 98304
  s_add_u32 s64, s67, 0
  buffer_load_dwordx4 v10, s[36:39], s64 offen lds
  s_add_u32 m0, s63, 102400
  s_add_u32 s64, s67, 28672
  buffer_load_dwordx4 v10, s[36:39], s64 offen lds
  s_add_u32 m0, s63, 106496
  s_add_u32 s64, s67, 57344
  buffer_load_dwordx4 v10, s[36:39], s64 offen lds
  s_add_u32 m0, s63, 110592
  s_add_u32 s64, s67, 86016
  buffer_load_dwordx4 v10, s[36:39], s64 offen lds
  s_add_u32 s83, s83, 1
  s_cmp_eq_u32 s83, 7
  s_cselect_b32 s83, 0, s83
  s_mul_i32 s64, s84, s66
  s_add_u32 s64, s64, s61
  s_add_u32 m0, s63, 114688
  s_nop 0
  buffer_load_dwordx4 v11, s[40:43], s64 offen lds
  s_add_u32 m0, s63, 118784
  s_add_u32 s64, s64, s65
  buffer_load_dwordx4 v11, s[40:43], s64 offen lds
  s_add_u32 m0, s63, 122880
  s_add_u32 s64, s64, s65
  buffer_load_dwordx4 v11, s[40:43], s64 offen lds
  s_add_u32 m0, s63, 126976
  s_add_u32 s64, s64, s65
  buffer_load_dwordx4 v11, s[40:43], s64 offen lds
  s_add_u32 s84, s84, 1
  s_cmp_eq_u32 s84, 7
  s_cselect_b32 s84, 0, s84
  s_cmp_eq_u32 s75, 0
  s_cbranch_scc1 LloadA2_4
  s_waitcnt vmcnt(8)
  s_barrier
  s_mul_i32 s64, s84, s66
  s_add_u32 s64, s64, s62
  s_add_u32 m0, s63, 131072
  s_nop 0
  buffer_load_dwordx4 v12, s[40:43], s64 offen lds
  s_add_u32 m0, s63, 135168
  s_add_u32 s64, s64, s65
  buffer_load_dwordx4 v12, s[40:43], s64 offen lds
  s_add_u32 m0, s63, 139264
  s_add_u32 s64, s64, s65
  buffer_load_dwordx4 v12, s[40:43], s64 offen lds
  s_add_u32 m0, s63, 143360
  s_add_u32 s64, s64, s65
  buffer_load_dwordx4 v12, s[40:43], s64 offen lds
  s_add_u32 s84, s84, 1
  s_cmp_eq_u32 s84, 7
  s_cselect_b32 s84, 0, s84
  s_waitcnt vmcnt(4)
  s_barrier
  s_mul_i32 s64, s84, s66
  s_add_u32 s64, s64, s62
  s_add_u32 m0, s63, 147456
  s_nop 0
  buffer_load_dwordx4 v12, s[40:43], s64 offen lds
  s_add_u32 m0, s63, 151552
  s_add_u32 s64, s64, s65
  buffer_load_dwordx4 v12, s[40:43], s64 offen lds
  s_add_u32 m0, s63, 155648
  s_add_u32 s64, s64, s65
  buffer_load_dwordx4 v12, s[40:43], s64 offen lds
  s_add_u32 m0, s63, 159744
  s_add_u32 s64, s64, s65
  buffer_load_dwordx4 v12, s[40:43], s64 offen lds
  s_add_u32 s84, s84, 1
  s_cmp_eq_u32 s84, 7
  s_cselect_b32 s84, 0, s84
  s_waitcnt vmcnt(4)
  s_barrier
  s_mul_i32 s64, s84, s66
  s_add_u32 s64, s64, s62
  s_add_u32 m0, s63, 114688
  s_nop 0
  buffer_load_dwordx4 v12, s[40:43], s64 offen lds
  s_add_u32 m0, s63, 118784
  s_add_u32 s64, s64, s65
  buffer_load_dwordx4 v12, s[40:43], s64 offen lds
  s_add_u32 m0, s63, 122880
  s_add_u32 s64, s64, s65
  buffer_load_dwordx4 v12, s[40:43], s64 offen lds
  s_add_u32 m0, s63, 126976
  s_add_u32 s64, s64, s65
  buffer_load_dwordx4 v12, s[40:43], s64 offen lds
  s_add_u32 s84, s84, 1
  s_cmp_eq_u32 s84, 7
  s_cselect_b32 s84, 0, s84
  s_waitcnt vmcnt(4)
  s_barrier
  s_mul_i32 s64, s84, s66
  s_add_u32 s64, s64, s62
  s_add_u32 m0, s63, 131072
  s_nop 0
  buffer_load_dwordx4 v12, s[40:43], s64 offen lds
  s_add_u32 m0, s63, 135168
  s_add_u32 s64, s64, s65
  buffer_load_dwordx4 v12, s[40:43], s64 offen lds
  s_add_u32 m0, s63, 139264
  s_add_u32 s64, s64, s65
  buffer_load_dwordx4 v12, s[40:43], s64 offen lds
  s_add_u32 m0, s63, 143360
  s_add_u32 s64, s64, s65
  buffer_load_dwordx4 v12, s[40:43], s64 offen lds
  s_add_u32 s84, s84, 1
  s_cmp_eq_u32 s84, 7
  s_cselect_b32 s84, 0, s84
  s_waitcnt vmcnt(4)
  s_barrier
  s_mul_i32 s64, s84, s66
  s_add_u32 s64, s64, s62
  s_add_u32 m0, s63, 147456
  s_nop 0
  buffer_load_dwordx4 v12, s[40:43], s64 offen lds
  s_add_u32 m0, s63, 151552
  s_add_u32 s64, s64, s65
  buffer_load_dwordx4 v12, s[40:43], s64 offen lds
  s_add_u32 m0, s63, 155648
  s_add_u32 s64, s64, s65
  buffer_load_dwordx4 v12, s[40:43], s64 offen lds
  s_add_u32 m0, s63, 159744
  s_add_u32 s64, s64, s65
  buffer_load_dwordx4 v12, s[40:43], s64 offen lds
  s_add_u32 s84, s84, 1
  s_cmp_eq_u32 s84, 7
  s_cselect_b32 s84, 0, s84
  s_waitcnt vmcnt(4)
  s_barrier
  s_mul_i32 s64, s84, s66
  s_add_u32 s64, s64, s62
  s_add_u32 m0, s63, 114688
  s_nop 0
  buffer_load_dwordx4 v12, s[40:43], s64 offen lds
  s_add_u32 m0, s63, 118784
  s_add_u32 s64, s64, s65
  buffer_load_dwordx4 v12, s[40:43], s64 offen lds
  s_add_u32 m0, s63, 122880
  s_add_u32 s64, s64, s65
  buffer_load_dwordx4 v12, s[40:43], s64 offen lds
  s_add_u32 m0, s63, 126976
  s_add_u32 s64, s64, s65
  buffer_load_dwordx4 v12, s[40:43], s64 offen lds
  s_add_u32 s84, s84, 1
  s_cmp_eq_u32 s84, 7
  s_cselect_b32 s84, 0, s84
  s_waitcnt vmcnt(4)
  s_barrier
  s_mul_i32 s64, s84, s66
  s_add_u32 s64, s64, s62
  s_add_u32 m0, s63, 131072
  s_nop 0
  buffer_load_dwordx4 v12, s[40:43], s64 offen lds
  s_add_u32 m0, s63, 135168
  s_add_u32 s64, s64, s65
  buffer_load_dwordx4 v12, s[40:43], s64 offen lds
  s_add_u32 m0, s63, 139264
  s_add_u32 s64, s64, s65
  buffer_load_dwordx4 v12, s[40:43], s64 offen lds
  s_add_u32 m0, s63, 143360
  s_add_u32 s64, s64, s65
  buffer_load_dwordx4 v12, s[40:43], s64 offen lds
  s_add_u32 s84, s84, 1
  s_cmp_eq_u32 s84, 7
  s_cselect_b32 s84, 0, s84
  s_mov_b32 s52, s16
  s_and_b32 s53, s17, 0xffff
  s_mov_b32 s54, 1605632
  s_mov_b32 s55, 0x20000
  s_mov_b32 s56, s8
  s_and_b32 s57, s9, 0xffff
  s_mov_b32 s58, 401408
  s_mov_b32 s59, 0x20000
  v_lshlrev_b32 v20, 4, v1
  v_lshrrev_b32 v7, 3, v1
  v_mul_u32_u24 v7, 896, v7
  v_bfe_u32 v9, v1, 4, 1
  v_lshlrev_b32 v9, 2, v9
  v_and_b32 v8, 7, v1
  v_xor_b32 v9, v9, v8
  v_lshl_add_u32 v21, v9, 4, v7
  v_lshlrev_b32 v22, 2, v8
  v_min_u32 v24, 8, v1
  v_lshlrev_b32 v24, 2, v24
  s_lshl_b32 s87, s29, 11
  s_mul_i32 s79, s72, 229376
  s_add_u32 s79, s79, 5242880
  s_add_u32 s79, s79, s87
  s_lshl_b32 s80, s72, 16
  s_add_u32 s80, s80, 3145728
  s_add_u32 s80, s80, s87
  s_lshl_b32 s81, s73, 7
  s_mul_i32 s35, s29, 14336
  s_add_u32 s81, s81, s35
  s_mul_i32 s78, s72, 3
  s_lshl_b32 s35, s73, 1
  s_add_u32 s78, s78, s35
  s_mul_i32 s35, s78, 171
  s_lshr_b32 s35, s35, 11
  s_mul_i32 s35, s35, 12
  s_sub_u32 s85, s78, s35
  s_and_b32 s86, s78, 7
  s_and_b32 s78, s78, 15
  v_min_u32 v25, 15, v1
  v_lshlrev_b32 v25, 2, v25
  s_lshl_b32 s91, s31, 7
  s_add_u32 s91, s91, 4096
  s_lshl_b32 s70, s31, 13
  s_add_u32 s70, s70, 65536
  s_add_u32 s70, s70, s87
  s_lshr_b32 s88, s72, 1
  s_lshl_b32 s88, s88, 7
  s_add_u32 s89, s88, 2048
  s_add_u32 s90, s88, 11264
  s_waitcnt vmcnt(4)
  s_barrier
  s_waitcnt vmcnt(0)
  s_barrier
  s_waitcnt lgkmcnt(0)
  s_mul_i32 s74, s74, 0x9E3779B1
  s_add_u32 s74, s74, 0x7F4A7C15
  buffer_load_dword v23, v22, s[44:47], s88 offen sc1
  s_barrier
  s_cmp_eq_u32 s76, 0
  s_cbranch_scc1 L_gl
  s_barrier
  s_mov_b32 s56, s8
  s_and_b32 s57, s9, 0xffff
  s_mov_b32 s58, 401408
  s_mov_b32 s59, 0x20000
  s_and_b32 s68, s34, 3
  s_lshl_b32 s68, s68, 2
  s_add_u32 s68, s68, s29
  s_mul_i32 s69, s68, 25088
  v_lshlrev_b32 v7, 7, v1
  buffer_load_dword v40, v7, s[56:59], s69 offen
  s_add_u32 s69, s69, 8192
  buffer_load_dword v41, v7, s[56:59], s69 offen
  s_add_u32 s69, s69, 8192
  buffer_load_dword v42, v7, s[56:59], s69 offen
  s_add_u32 s69, s69, 8192
  v_cmp_gt_u32 vcc, 4, v1
  v_or_b32 v8, 0x40000000, v7
  s_nop 0
  v_cndmask_b32 v7, v8, v7, vcc
  buffer_load_dword v43, v7, s[56:59], s69 offen
  s_add_u32 s69, s69, 8192
  s_endpgm
LloadA2_4:
  s_waitcnt vmcnt(8)
  s_barrier
  s_mul_i32 s67, s84, 172032
  s_add_u32 s67, s67, s82
  s_lshl_b32 s64, s29, 11
  s_add_u32 m0, s64, 131072
  s_nop 0
  buffer_load_dwordx4 v13, s[40:43], s67 offen lds
  s_add_u32 m0, s64, 132096
  s_add_u32 s67, s67, 21504
  buffer_load_dwordx4 v13, s[40:43], s67 offen lds
  s_add_u32 s84, s84, 1
  s_cmp_eq_u32 s84, 7
  s_cselect_b32 s84, 0, s84
  s_waitcnt vmcnt(2)
  s_barrier
  s_mul_i32 s67, s84, 172032
  s_add_u32 s67, s67, s82
  s_lshl_b32 s64, s29, 11
  s_add_u32 m0, s64, 147456
  s_nop 0
  buffer_load_dwordx4 v13, s[40:43], s67 offen lds
  s_add_u32 m0, s64, 148480
  s_add_u32 s67, s67, 21504
  buffer_load_dwordx4 v13, s[40:43], s67 offen lds
  s_add_u32 s84, s84, 1
  s_cmp_eq_u32 s84, 7
  s_cselect_b32 s84, 0, s84
  s_waitcnt vmcnt(2)
  s_barrier
  s_mul_i32 s67, s84, 172032
  s_add_u32 s67, s67, s82
  s_lshl_b32 s64, s29, 11
  s_add_u32 m0, s64, 114688
  s_nop 0
  buffer_load_dwordx4 v13, s[40:43], s67 offen lds
  s_add_u32 m0, s64, 115712
  s_add_u32 s67, s67, 21504
  buffer_load_dwordx4 v13, s[40:43], s67 offen lds
  s_add_u32 s84, s84, 1
  s_cmp_eq_u32 s84, 7
  s_cselect_b32 s84, 0, s84
  s_barrier
  s_waitcnt vmcnt(2)
  s_barrier
  s_mul_i32 s67, s84, 172032
  s_add_u32 s67, s67, s82
  s_lshl_b32 s64, s29, 11
  s_add_u32 m0, s64, 131072
  s_nop 0
  buffer_load_dwordx4 v13, s[40:43], s67 offen lds
  s_add_u32 m0, s64, 132096
  s_add_u32 s67, s67, 21504
  buffer_load_dwordx4 v13, s[40:43], s67 offen lds
  s_add_u32 s84, s84, 1
  s_cmp_eq_u32 s84, 7
  s_cselect_b32 s84, 0, s84
  s_waitcnt vmcnt(2)
  s_barrier
  s_mul_i32 s67, s84, 172032
  s_add_u32 s67, s67, s82
  s_lshl_b32 s64, s29, 11
  s_add_u32 m0, s64, 147456
  s_nop 0
  buffer_load_dwordx4 v13, s[40:43], s67 offen lds
  s_add_u32 m0, s64, 148480
  s_add_u32 s67, s67, 21504
  buffer_load_dwordx4 v13, s[40:43], s67 offen lds
  s_add_u32 s84, s84, 1
  s_cmp_eq_u32 s84, 7
  s_cselect_b32 s84, 0, s84
  s_waitcnt vmcnt(2)
  s_barrier
  s_mul_i32 s67, s84, 172032
  s_add_u32 s67, s67, s82
  s_lshl_b32 s64, s29, 11
  s_add_u32 m0, s64, 114688
  s_nop 0
  buffer_load_dwordx4 v13, s[40:43], s67 offen lds
  s_add_u32 m0, s64, 115712
  s_add_u32 s67, s67, 21504
  buffer_load_dwordx4 v13, s[40:43], s67 offen lds
  s_add_u32 s84, s84, 1
  s_cmp_eq_u32 s84, 7
  s_cselect_b32 s84, 0, s84
  s_waitcnt vmcnt(2)
  s_barrier
  s_mul_i32 s67, s84, 172032
  s_add_u32 s67, s67, s82
  s_lshl_b32 s64, s29, 11
  s_add_u32 m0, s64, 131072
  s_nop 0
  buffer_load_dwordx4 v13, s[40:43], s67 offen lds
  s_add_u32 m0, s64, 132096
  s_add_u32 s67, s67, 21504
  buffer_load_dwordx4 v13, s[40:43], s67 offen lds
  s_add_u32 s84, s84, 1
  s_cmp_eq_u32 s84, 7
  s_cselect_b32 s84, 0, s84
  s_mov_b32 s52, s16
  s_and_b32 s53, s17, 0xffff
  s_mov_b32 s54, 1605632
  s_mov_b32 s55, 0x20000
  s_mov_b32 s56, s8
  s_and_b32 s57, s9, 0xffff
  s_mov_b32 s58, 401408
  s_mov_b32 s59, 0x20000
  v_lshlrev_b32 v20, 4, v1
  v_lshrrev_b32 v7, 3, v1
  v_mul_u32_u24 v7, 896, v7
  v_bfe_u32 v9, v1, 4, 1
  v_lshlrev_b32 v9, 2, v9
  v_and_b32 v8, 7, v1
  v_xor_b32 v9, v9, v8
  v_lshl_add_u32 v21, v9, 4, v7
  v_lshlrev_b32 v22, 2, v8
  v_min_u32 v24, 8, v1
  v_lshlrev_b32 v24, 2, v24
  s_lshl_b32 s87, s29, 11
  s_mul_i32 s79, s72, 229376
  s_add_u32 s79, s79, 5242880
  s_add_u32 s79, s79, s87
  s_lshl_b32 s80, s72, 16
  s_add_u32 s80, s80, 3145728
  s_add_u32 s80, s80, s87
  s_lshl_b32 s81, s73, 7
  s_mul_i32 s35, s29, 14336
  s_add_u32 s81, s81, s35
  s_mul_i32 s78, s72, 3
  s_lshl_b32 s35, s73, 1
  s_add_u32 s78, s78, s35
  s_mul_i32 s35, s78, 171
  s_lshr_b32 s35, s35, 11
  s_mul_i32 s35, s35, 12
  s_sub_u32 s85, s78, s35
  s_and_b32 s86, s78, 7
  s_and_b32 s78, s78, 15
  v_min_u32 v25, 15, v1
  v_lshlrev_b32 v25, 2, v25
  s_lshl_b32 s91, s31, 7
  s_add_u32 s91, s91, 4096
  s_lshl_b32 s70, s31, 13
  s_add_u32 s70, s70, 65536
  s_add_u32 s70, s70, s87
  s_lshr_b32 s88, s72, 1
  s_lshl_b32 s88, s88, 7
  s_add_u32 s89, s88, 2048
  s_add_u32 s90, s88, 11264
  s_waitcnt vmcnt(2)
  s_barrier
  s_waitcnt vmcnt(0)
  s_barrier
  s_waitcnt lgkmcnt(0)
  s_mul_i32 s74, s74, 0x9E3779B1
  s_add_u32 s74, s74, 0x7F4A7C15
  buffer_load_dword v23, v22, s[44:47], s88 offen sc1
  s_barrier
  s_cmp_eq_u32 s76, 0
  s_cbranch_scc1 L_gl
  s_lshl_b32 s67, s84, 7
  s_add_u32 m0, s63, 147456
  s_nop 0
  buffer_load_dwordx4 v19, s[48:51], s67 offen lds
  s_add_u32 s84, s84, 1
  s_cmp_eq_u32 s84, 7
  s_cselect_b32 s84, 0, s84
  s_lshl_b32 s67, s84, 7
  s_add_u32 m0, s63, 114688
  s_nop 0
  buffer_load_dwordx4 v19, s[48:51], s67 offen lds
  s_add_u32 s84, s84, 1
  s_cmp_eq_u32 s84, 7
  s_cselect_b32 s84, 0, s84
  s_lshl_b32 s67, s84, 7
  s_add_u32 m0, s63, 131072
  s_nop 0
  buffer_load_dwordx4 v19, s[48:51], s67 offen lds
  s_add_u32 s84, s84, 1
  s_cmp_eq_u32 s84, 7
  s_cselect_b32 s84, 0, s84
  s_barrier
  s_waitcnt vmcnt(2)
  s_barrier
  s_waitcnt vmcnt(1)
  s_barrier
  s_lshl_b32 s67, s84, 7
  s_add_u32 m0, s63, 147456
  s_nop 0
  buffer_load_dwordx4 v19, s[48:51], s67 offen lds
  s_add_u32 s84, s84, 1
  s_cmp_eq_u32 s84, 7
  s_cselect_b32 s84, 0, s84
  s_waitcnt vmcnt(1)
  s_barrier
  s_lshl_b32 s67, s84, 7
  s_add_u32 m0, s63, 114688
  s_nop 0
  buffer_load_dwordx4 v19, s[48:51], s67 offen lds
  s_add_u32 s84, s84, 1
  s_cmp_eq_u32 s84, 7
  s_cselect_b32 s84, 0, s84
  s_waitcnt vmcnt(1)
  s_barrier
  s_lshl_b32 s67, s84, 7
  s_add_u32 m0, s63, 131072
  s_nop 0
  buffer_load_dwordx4 v19, s[48:51], s67 offen lds
  s_add_u32 s84, s84, 1
  s_cmp_eq_u32 s84, 7
  s_cselect_b32 s84, 0, s84
  s_waitcnt vmcnt(1)
  s_barrier
  s_lshl_b32 s67, s84, 7
  s_add_u32 m0, s63, 147456
  s_nop 0
  buffer_load_dwordx4 v19, s[48:51], s67 offen lds
  s_add_u32 s84, s84, 1
  s_cmp_eq_u32 s84, 7
  s_cselect_b32 s84, 0, s84
  s_waitcnt vmcnt(1)
  s_barrier
  s_waitcnt vmcnt(0)
  s_barrier
  s_barrier
  s_barrier
  s_mov_b32 s56, s8
  s_and_b32 s57, s9, 0xffff
  s_mov_b32 s58, 401408
  s_mov_b32 s59, 0x20000
  s_and_b32 s68, s34, 3
  s_lshl_b32 s68, s68, 2
  s_add_u32 s68, s68, s29
  s_mul_i32 s69, s68, 25088
  v_lshlrev_b32 v7, 7, v1
  buffer_load_dword v40, v7, s[56:59], s69 offen
  s_add_u32 s69, s69, 8192
  buffer_load_dword v41, v7, s[56:59], s69 offen
  s_add_u32 s69, s69, 8192
  buffer_load_dword v42, v7, s[56:59], s69 offen
  s_add_u32 s69, s69, 8192
  v_cmp_gt_u32 vcc, 4, v1
  v_or_b32 v8, 0x40000000, v7
  s_nop 0
  v_cndmask_b32 v7, v8, v7, vcc
  buffer_load_dword v43, v7, s[56:59], s69 offen
  s_add_u32 s69, s69, 8192
  s_endpgm
L_gl:
  s_add_u32 s69, s85, 0
  s_cmp_ge_u32 s69, 12
  s_cselect_b32 s68, 12, 0
  s_sub_u32 s69, s69, s68
  s_mul_i32 s68, s69, 43
  s_lshr_b32 s68, s68, 7
  s_lshl_b32 s35, s68, 2
  s_add_u32 s68, s35, s69
  s_add_u32 s68, s68, 2
  s_mul_i32 s71, s68, 57344
  s_add_u32 s71, s71, s81
  s_add_u32 m0, s87, 8192
  s_nop 0
  buffer_load_dwordx4 v21, s[52:55], s71 offen lds
  s_add_u32 m0, s87, 9216
  s_add_u32 s71, s71, 7168
  buffer_load_dwordx4 v21, s[52:55], s71 offen lds
  s_waitcnt vmcnt(2)
  v_cmp_ne_u32 vcc, s74, v23
  s_cbranch_vccz Lok_5
  s_mov_b32 s95, 0x8000
Lpoll_6:
  buffer_load_dword v23, v22, s[44:47], s88 offen sc1
  s_waitcnt vmcnt(0)
  v_cmp_ne_u32 vcc, s74, v23
  s_cbranch_vccz Lpdone_7
  s_sleep 1
  s_sub_u32 s95, s95, 1
  s_cmp_lg_u32 s95, 0
  s_cbranch_scc1 Lpoll_6
Lpdone_7:
Lok_5:
  s_add_u32 s69, s85, 0
  s_cmp_ge_u32 s69, 12
  s_cselect_b32 s68, 12, 0
  s_sub_u32 s69, s69, s68
  s_mul_i32 s68, s69, 43
  s_lshr_b32 s68, s68, 7
  s_lshl_b32 s35, s68, 2
  s_add_u32 s68, s35, s69
  s_add_u32 s68, s68, 2
  s_lshl_b32 s71, s68, 13
  s_add_u32 s71, s71, s79
  s_add_u32 m0, s87, 0
  s_nop 0
  buffer_load_dwordx4 v20, s[44:47], s71 offen sc1 lds
  s_add_u32 m0, s87, 1024
  s_add_u32 s71, s71, 1024
  buffer_load_dwordx4 v20, s[44:47], s71 offen sc1 lds
  s_add_u32 s69, s85, 1
  s_cmp_ge_u32 s69, 12
  s_cselect_b32 s68, 12, 0
  s_sub_u32 s69, s69, s68
  s_mul_i32 s68, s69, 43
  s_lshr_b32 s68, s68, 7
  s_lshl_b32 s35, s68, 2
  s_add_u32 s68, s35, s69
  s_add_u32 s68, s68, 2
  s_mul_i32 s71, s68, 57344
  s_add_u32 s71, s71, s81
  s_add_u32 m0, s87, 24576
  s_nop 0
  buffer_load_dwordx4 v21, s[52:55], s71 offen lds
  s_add_u32 m0, s87, 25600
  s_add_u32 s71, s71, 7168
  buffer_load_dwordx4 v21, s[52:55], s71 offen lds
  s_add_u32 s69, s85, 1
  s_cmp_ge_u32 s69, 12
  s_cselect_b32 s68, 12, 0
  s_sub_u32 s69, s69, s68
  s_mul_i32 s68, s69, 43
  s_lshr_b32 s68, s68, 7
  s_lshl_b32 s35, s68, 2
  s_add_u32 s68, s35, s69
  s_add_u32 s68, s68, 2
  s_lshl_b32 s71, s68, 13
  s_add_u32 s71, s71, s79
  s_add_u32 m0, s87, 16384
  s_nop 0
  buffer_load_dwordx4 v20, s[44:47], s71 offen sc1 lds
  s_add_u32 m0, s87, 17408
  s_add_u32 s71, s71, 1024
  buffer_load_dwordx4 v20, s[44:47], s71 offen sc1 lds
  s_barrier
  s_waitcnt vmcnt(4)
  s_barrier
  s_add_u32 s69, s85, 2
  s_cmp_ge_u32 s69, 12
  s_cselect_b32 s68, 12, 0
  s_sub_u32 s69, s69, s68
  s_mul_i32 s68, s69, 43
  s_lshr_b32 s68, s68, 7
  s_lshl_b32 s35, s68, 2
  s_add_u32 s68, s35, s69
  s_add_u32 s68, s68, 2
  s_mul_i32 s71, s68, 57344
  s_add_u32 s71, s71, s81
  s_add_u32 m0, s87, 40960
  s_nop 0
  buffer_load_dwordx4 v21, s[52:55], s71 offen lds
  s_add_u32 m0, s87, 41984
  s_add_u32 s71, s71, 7168
  buffer_load_dwordx4 v21, s[52:55], s71 offen lds
  s_add_u32 s69, s85, 2
  s_cmp_ge_u32 s69, 12
  s_cselect_b32 s68, 12, 0
  s_sub_u32 s69, s69, s68
  s_mul_i32 s68, s69, 43
  s_lshr_b32 s68, s68, 7
  s_lshl_b32 s35, s68, 2
  s_add_u32 s68, s35, s69
  s_add_u32 s68, s68, 2
  s_lshl_b32 s71, s68, 13
  s_add_u32 s71, s71, s79
  s_add_u32 m0, s87, 32768
  s_nop 0
  buffer_load_dwordx4 v20, s[44:47], s71 offen sc1 lds
  s_add_u32 m0, s87, 33792
  s_add_u32 s71, s71, 1024
  buffer_load_dwordx4 v20, s[44:47], s71 offen sc1 lds
  s_waitcnt vmcnt(4)
  s_barrier
  s_cmp_eq_u32 s75, 1
  s_cbranch_scc1 Lkx_8
  buffer_load_dword v26, v25, s[44:47], s91 offen sc1
Lkx_8:
  s_add_u32 s69, s85, 3
  s_cmp_ge_u32 s69, 12
  s_cselect_b32 s68, 12, 0
  s_sub_u32 s69, s69, s68
  s_mul_i32 s68, s69, 43
  s_lshr_b32 s68, s68, 7
  s_lshl_b32 s35, s68, 2
  s_add_u32 s68, s35, s69
  s_add_u32 s68, s68, 2
  s_mul_i32 s71, s68, 57344
  s_add_u32 s71, s71, s81
  s_add_u32 m0, s87, 57344
  s_nop 0
  buffer_load_dwordx4 v21, s[52:55], s71 offen lds
  s_add_u32 m0, s87, 58368
  s_add_u32 s71, s71, 7168
  buffer_load_dwordx4 v21, s[52:55], s71 offen lds
  s_add_u32 s69, s85, 3
  s_cmp_ge_u32 s69, 12
  s_cselect_b32 s68, 12, 0
  s_sub_u32 s69, s69, s68
  s_mul_i32 s68, s69, 43
  s_lshr_b32 s68, s68, 7
  s_lshl_b32 s35, s68, 2
  s_add_u32 s68, s35, s69
  s_add_u32 s68, s68, 2
  s_lshl_b32 s71, s68, 13
  s_add_u32 s71, s71, s79
  s_add_u32 m0, s87, 49152
  s_nop 0
  buffer_load_dwordx4 v20, s[44:47], s71 offen sc1 lds
  s_add_u32 m0, s87, 50176
  s_add_u32 s71, s71, 1024
  buffer_load_dwordx4 v20, s[44:47], s71 offen sc1 lds
  s_add_u32 s69, s85, 4
  s_cmp_ge_u32 s69, 12
  s_cselect_b32 s68, 12, 0
  s_sub_u32 s69, s69, s68
  s_mul_i32 s68, s69, 43
  s_lshr_b32 s68, s68, 7
  s_lshl_b32 s35, s68, 2
  s_add_u32 s68, s35, s69
  s_add_u32 s68, s68, 2
  s_mul_i32 s71, s68, 57344
  s_add_u32 s71, s71, s81
  s_add_u32 m0, s87, 73728
  s_nop 0
  buffer_load_dwordx4 v21, s[52:55], s71 offen lds
  s_add_u32 m0, s87, 74752
  s_add_u32 s71, s71, 7168
  buffer_load_dwordx4 v21, s[52:55], s71 offen lds
  s_add_u32 s69, s85, 4
  s_cmp_ge_u32 s69, 12
  s_cselect_b32 s68, 12, 0
  s_sub_u32 s69, s69, s68
  s_mul_i32 s68, s69, 43
  s_lshr_b32 s68, s68, 7
  s_lshl_b32 s35, s68, 2
  s_add_u32 s68, s35, s69
  s_add_u32 s68, s68, 2
  s_lshl_b32 s71, s68, 13
  s_add_u32 s71, s71, s79
  s_add_u32 m0, s87, 65536
  s_nop 0
  buffer_load_dwordx4 v20, s[44:47], s71 offen sc1 lds
  s_add_u32 m0, s87, 66560
  s_add_u32 s71, s71, 1024
  buffer_load_dwordx4 v20, s[44:47], s71 offen sc1 lds
  s_add_u32 s69, s85, 5
  s_cmp_ge_u32 s69, 12
  s_cselect_b32 s68, 12, 0
  s_sub_u32 s69, s69, s68
  s_mul_i32 s68, s69, 43
  s_lshr_b32 s68, s68, 7
  s_lshl_b32 s35, s68, 2
  s_add_u32 s68, s35, s69
  s_add_u32 s68, s68, 2
  s_mul_i32 s71, s68, 57344
  s_add_u32 s71, s71, s81
  s_add_u32 m0, s87, 90112
  s_nop 0
  buffer_load_dwordx4 v21, s[52:55], s71 offen lds
  s_add_u32 m0, s87, 91136
  s_add_u32 s71, s71, 7168
  buffer_load_dwordx4 v21, s[52:55], s71 offen lds
  s_waitcnt vmcnt(10)
  s_barrier
  s_add_u32 s69, s85, 5
  s_cmp_ge_u32 s69, 12
  s_cselect_b32 s68, 12, 0
  s_sub_u32 s69, s69, s68
  s_mul_i32 s68, s69, 43
  s_lshr_b32 s68, s68, 7
  s_lshl_b32 s35, s68, 2
  s_add_u32 s68, s35, s69
  s_add_u32 s68, s68, 2
  s_lshl_b32 s71, s68, 13
  s_add_u32 s71, s71, s79
  s_add_u32 m0, s87, 81920
  s_nop 0
  buffer_load_dwordx4 v20, s[44:47], s71 offen sc1 lds
  s_add_u32 m0, s87, 82944
  s_add_u32 s71, s71, 1024
  buffer_load_dwordx4 v20, s[44:47], s71 offen sc1 lds
  s_add_u32 s69, s85, 6
  s_cmp_ge_u32 s69, 12
  s_cselect_b32 s68, 12, 0
  s_sub_u32 s69, s69, s68
  s_mul_i32 s68, s69, 43
  s_lshr_b32 s68, s68, 7
  s_lshl_b32 s35, s68, 2
  s_add_u32 s68, s35, s69
  s_add_u32 s68, s68, 2
  s_mul_i32 s71, s68, 57344
  s_add_u32 s71, s71, s81
  s_add_u32 m0, s87, 106496
  s_nop 0
  buffer_load_dwordx4 v21, s[52:55], s71 offen lds
  s_add_u32 m0, s87, 107520
  s_add_u32 s71, s71, 7168
  buffer_load_dwordx4 v21, s[52:55], s71 offen lds
  s_add_u32 s69, s85, 6
  s_cmp_ge_u32 s69, 12
  s_cselect_b32 s68, 12, 0
  s_sub_u32 s69, s69, s68
  s_mul_i32 s68, s69, 43
  s_lshr_b32 s68, s68, 7
  s_lshl_b32 s35, s68, 2
  s_add_u32 s68, s35, s69
  s_add_u32 s68, s68, 2
  s_lshl_b32 s71, s68, 13
  s_add_u32 s71, s71, s79
  s_add_u32 m0, s87, 98304
  s_nop 0
  buffer_load_dwordx4 v20, s[44:47], s71 offen sc1 lds
  s_add_u32 m0, s87, 99328
  s_add_u32 s71, s71, 1024
  buffer_load_dwordx4 v20, s[44:47], s71 offen sc1 lds
  s_add_u32 s69, s85, 7
  s_cmp_ge_u32 s69, 12
  s_cselect_b32 s68, 12, 0
  s_sub_u32 s69, s69, s68
  s_mul_i32 s68, s69, 43
  s_lshr_b32 s68, s68, 7
  s_lshl_b32 s35, s68, 2
  s_add_u32 s68, s35, s69
  s_add_u32 s68, s68, 2
  s_mul_i32 s71, s68, 57344
  s_add_u32 s71, s71, s81
  s_add_u32 m0, s87, 122880
  s_nop 0
  buffer_load_dwordx4 v21, s[52:55], s71 offen lds
  s_add_u32 m0, s87, 123904
  s_add_u32 s71, s71, 7168
  buffer_load_dwordx4 v21, s[52:55], s71 offen lds
  s_waitcnt vmcnt(14)
  s_barrier
  s_cmp_eq_u32 s75, 1
  s_cbranch_scc1 Lkx_9
  s_waitcnt vmcnt(18)
  v_cmp_ne_u32 vcc, s74, v26
  s_cbranch_vccz Lkok_10
  s_mov_b32 s95, 0x8000
Lpoll_11:
  buffer_load_dword v26, v25, s[44:47], s91 offen sc1
  s_waitcnt vmcnt(0)
  v_cmp_ne_u32 vcc, s74, v26
  s_cbranch_vccz Lpdone_12
  s_sleep 1
  s_sub_u32 s95, s95, 1
  s_cmp_lg_u32 s95, 0
  s_cbranch_scc1 Lpoll_11
Lpdone_12:
Lkok_10:
  s_add_u32 m0, s87, 147456
  s_add_u32 s71, s70, 0
  buffer_load_dwordx4 v20, s[44:47], s71 offen sc1 lds
  s_add_u32 m0, s87, 148480
  s_add_u32 s71, s70, 1024
  buffer_load_dwordx4 v20, s[44:47], s71 offen sc1 lds
Lkx_9:
  s_add_u32 s69, s85, 7
  s_cmp_ge_u32 s69, 12
  s_cselect_b32 s68, 12, 0
  s_sub_u32 s69, s69, s68
  s_mul_i32 s68, s69, 43
  s_lshr_b32 s68, s68, 7
  s_lshl_b32 s35, s68, 2
  s_add_u32 s68, s35, s69
  s_add_u32 s68, s68, 2
  s_lshl_b32 s71, s68, 13
  s_add_u32 s71, s71, s79
  s_add_u32 m0, s87, 114688
  s_nop 0
  buffer_load_dwordx4 v20, s[44:47], s71 offen sc1 lds
  s_add_u32 m0, s87, 115712
  s_add_u32 s71, s71, 1024
  buffer_load_dwordx4 v20, s[44:47], s71 offen sc1 lds
  s_add_u32 s69, s85, 8
  s_cmp_ge_u32 s69, 12
  s_cselect_b32 s68, 12, 0
  s_sub_u32 s69, s69, s68
  s_mul_i32 s68, s69, 43
  s_lshr_b32 s68, s68, 7
  s_lshl_b32 s35, s68, 2
  s_add_u32 s68, s35, s69
  s_add_u32 s68, s68, 2
  s_mul_i32 s71, s68, 57344
  s_add_u32 s71, s71, s81
  s_add_u32 m0, s87, 139264
  s_nop 0
  buffer_load_dwordx4 v21, s[52:55], s71 offen lds
  s_add_u32 m0, s87, 140288
  s_add_u32 s71, s71, 7168
  buffer_load_dwordx4 v21, s[52:55], s71 offen lds
  s_add_u32 s69, s85, 8
  s_cmp_ge_u32 s69, 12
  s_cselect_b32 s68, 12, 0
  s_sub_u32 s69, s69, s68
  s_mul_i32 s68, s69, 43
  s_lshr_b32 s68, s68, 7
  s_lshl_b32 s35, s68, 2
  s_add_u32 s68, s35, s69
  s_add_u32 s68, s68, 2
  s_lshl_b32 s71, s68, 13
  s_add_u32 s71, s71, s79
  s_add_u32 m0, s87, 131072
  s_nop 0
  buffer_load_dwordx4 v20, s[44:47], s71 offen sc1 lds
  s_add_u32 m0, s87, 132096
  s_add_u32 s71, s71, 1024
  buffer_load_dwordx4 v20, s[44:47], s71 offen sc1 lds
  s_add_u32 s69, s85, 9
  s_cmp_ge_u32 s69, 12
  s_cselect_b32 s68, 12, 0
  s_sub_u32 s69, s69, s68
  s_mul_i32 s68, s69, 43
  s_lshr_b32 s68, s68, 7
  s_lshl_b32 s35, s68, 2
  s_add_u32 s68, s35, s69
  s_add_u32 s68, s68, 2
  s_mul_i32 s71, s68, 57344
  s_add_u32 s71, s71, s81
  s_add_u32 m0, s87, 8192
  s_nop 0
  buffer_load_dwordx4 v21, s[52:55], s71 offen lds
  s_add_u32 m0, s87, 9216
  s_add_u32 s71, s71, 7168
  buffer_load_dwordx4 v21, s[52:55], s71 offen lds
  s_waitcnt vmcnt(18)
  s_barrier
  s_add_u32 s69, s85, 9
  s_cmp_ge_u32 s69, 12
  s_cselect_b32 s68, 12, 0
  s_sub_u32 s69, s69, s68
  s_mul_i32 s68, s69, 43
  s_lshr_b32 s68, s68, 7
  s_lshl_b32 s35, s68, 2
  s_add_u32 s68, s35, s69
  s_add_u32 s68, s68, 2
  s_lshl_b32 s71, s68, 13
  s_add_u32 s71, s71, s79
  s_add_u32 m0, s87, 0
  s_nop 0
  buffer_load_dwordx4 v20, s[44:47], s71 offen sc1 lds
  s_add_u32 m0, s87, 1024
  s_add_u32 s71, s71, 1024
  buffer_load_dwordx4 v20, s[44:47], s71 offen sc1 lds
  s_add_u32 s69, s85, 10
  s_cmp_ge_u32 s69, 12
  s_cselect_b32 s68, 12, 0
  s_sub_u32 s69, s69, s68
  s_mul_i32 s68, s69, 43
  s_lshr_b32 s68, s68, 7
  s_lshl_b32 s35, s68, 2
  s_add_u32 s68, s35, s69
  s_add_u32 s68, s68, 2
  s_mul_i32 s71, s68, 57344
  s_add_u32 s71, s71, s81
  s_add_u32 m0, s87, 24576
  s_nop 0
  buffer_load_dwordx4 v21, s[52:55], s71 offen lds
  s_add_u32 m0, s87, 25600
  s_add_u32 s71, s71, 7168
  buffer_load_dwordx4 v21, s[52:55], s71 offen lds
  s_waitcnt vmcnt(18)
  s_barrier
  s_add_u32 s69, s85, 10
  s_cmp_ge_u32 s69, 12
  s_cselect_b32 s68, 12, 0
  s_sub_u32 s69, s69, s68
  s_mul_i32 s68, s69, 43
  s_lshr_b32 s68, s68, 7
  s_lshl_b32 s35, s68, 2
  s_add_u32 s68, s35, s69
  s_add_u32 s68, s68, 2
  s_lshl_b32 s71, s68, 13
  s_add_u32 s71, s71, s79
  s_add_u32 m0, s87, 16384
  s_nop 0
  buffer_load_dwordx4 v20, s[44:47], s71 offen sc1 lds
  s_add_u32 m0, s87, 17408
  s_add_u32 s71, s71, 1024
  buffer_load_dwordx4 v20, s[44:47], s71 offen sc1 lds
  s_add_u32 s69, s85, 11
  s_cmp_ge_u32 s69, 12
  s_cselect_b32 s68, 12, 0
  s_sub_u32 s69, s69, s68
  s_mul_i32 s68, s69, 43
  s_lshr_b32 s68, s68, 7
  s_lshl_b32 s35, s68, 2
  s_add_u32 s68, s35, s69
  s_add_u32 s68, s68, 2
  s_mul_i32 s71, s68, 57344
  s_add_u32 s71, s71, s81
  s_add_u32 m0, s87, 40960
  s_nop 0
  buffer_load_dwordx4 v21, s[52:55], s71 offen lds
  s_add_u32 m0, s87, 41984
  s_add_u32 s71, s71, 7168
  buffer_load_dwordx4 v21, s[52:55], s71 offen lds
  s_waitcnt vmcnt(18)
  s_barrier
  s_add_u32 s69, s85, 11
  s_cmp_ge_u32 s69, 12
  s_cselect_b32 s68, 12, 0
  s_sub_u32 s69, s69, s68
  s_mul_i32 s68, s69, 43
  s_lshr_b32 s68, s68, 7
  s_lshl_b32 s35, s68, 2
  s_add_u32 s68, s35, s69
  s_add_u32 s68, s68, 2
  s_lshl_b32 s71, s68, 13
  s_add_u32 s71, s71, s79
  s_add_u32 m0, s87, 32768
  s_nop 0
  buffer_load_dwordx4 v20, s[44:47], s71 offen sc1 lds
  s_add_u32 m0, s87, 33792
  s_add_u32 s71, s71, 1024
  buffer_load_dwordx4 v20, s[44:47], s71 offen sc1 lds
  s_add_u32 s69, s78, 0
  s_and_b32 s69, s69, 15
  s_lshr_b32 s68, s69, 2
  s_mul_i32 s68, s68, 7
  s_and_b32 s69, s69, 3
  s_add_u32 s68, s68, s69
  s_cmp_ge_u32 s69, 2
  s_cselect_b32 s69, 3, 0
  s_add_u32 s68, s68, s69
  s_mul_i32 s71, s68, 57344
  s_add_u32 s71, s71, s81
  s_add_u32 m0, s87, 57344
  s_nop 0
  buffer_load_dwordx4 v21, s[52:55], s71 offen lds
  s_add_u32 m0, s87, 58368
  s_add_u32 s71, s71, 7168
  buffer_load_dwordx4 v21, s[52:55], s71 offen lds
  s_waitcnt vmcnt(18)
  s_barrier
  buffer_load_dword v23, v22, s[44:47], s89 offen sc1
  s_add_u32 s69, s78, 1
  s_and_b32 s69, s69, 15
  s_lshr_b32 s68, s69, 2
  s_mul_i32 s68, s68, 7
  s_and_b32 s69, s69, 3
  s_add_u32 s68, s68, s69
  s_cmp_ge_u32 s69, 2
  s_cselect_b32 s69, 3, 0
  s_add_u32 s68, s68, s69
  s_mul_i32 s71, s68, 57344
  s_add_u32 s71, s71, s81
  s_add_u32 m0, s87, 73728
  s_nop 0
  buffer_load_dwordx4 v21, s[52:55], s71 offen lds
  s_add_u32 m0, s87, 74752
  s_add_u32 s71, s71, 7168
  buffer_load_dwordx4 v21, s[52:55], s71 offen lds
  s_waitcnt vmcnt(17)
  s_barrier
  s_add_u32 s69, s78, 2
  s_and_b32 s69, s69, 15
  s_lshr_b32 s68, s69, 2
  s_mul_i32 s68, s68, 7
  s_and_b32 s69, s69, 3
  s_add_u32 s68, s68, s69
  s_cmp_ge_u32 s69, 2
  s_cselect_b32 s69, 3, 0
  s_add_u32 s68, s68, s69
  s_mul_i32 s71, s68, 57344
  s_add_u32 s71, s71, s81
  s_add_u32 m0, s87, 90112
  s_nop 0
  buffer_load_dwordx4 v21, s[52:55], s71 offen lds
  s_add_u32 m0, s87, 91136
  s_add_u32 s71, s71, 7168
  buffer_load_dwordx4 v21, s[52:55], s71 offen lds
  s_waitcnt vmcnt(15)
  s_barrier
  s_waitcnt vmcnt(4)
  v_cmp_ne_u32 vcc, s74, v23
  s_cbranch_vccz Lok_13
  s_mov_b32 s95, 0x8000
Lpoll_14:
  buffer_load_dword v23, v22, s[44:47], s89 offen sc1
  s_waitcnt vmcnt(0)
  v_cmp_ne_u32 vcc, s74, v23
  s_cbranch_vccz Lpdone_15
  s_sleep 1
  s_sub_u32 s95, s95, 1
  s_cmp_lg_u32 s95, 0
  s_cbranch_scc1 Lpoll_14
Lpdone_15:
Lok_13:
  s_add_u32 s69, s78, 0
  s_and_b32 s69, s69, 15
  s_lshr_b32 s68, s69, 2
  s_mul_i32 s68, s68, 7
  s_and_b32 s69, s69, 3
  s_add_u32 s68, s68, s69
  s_cmp_ge_u32 s69, 2
  s_cselect_b32 s69, 3, 0
  s_add_u32 s68, s68, s69
  s_lshl_b32 s71, s68, 13
  s_add_u32 s71, s71, s79
  s_add_u32 m0, s87, 49152
  s_nop 0
  buffer_load_dwordx4 v20, s[44:47], s71 offen sc1 lds
  s_add_u32 m0, s87, 50176
  s_add_u32 s71, s71, 1024
  buffer_load_dwordx4 v20, s[44:47], s71 offen sc1 lds
  s_add_u32 s69, s78, 1
  s_and_b32 s69, s69, 15
  s_lshr_b32 s68, s69, 2
  s_mul_i32 s68, s68, 7
  s_and_b32 s69, s69, 3
  s_add_u32 s68, s68, s69
  s_cmp_ge_u32 s69, 2
  s_cselect_b32 s69, 3, 0
  s_add_u32 s68, s68, s69
  s_lshl_b32 s71, s68, 13
  s_add_u32 s71, s71, s79
  s_add_u32 m0, s87, 65536
  s_nop 0
  buffer_load_dwordx4 v20, s[44:47], s71 offen sc1 lds
  s_add_u32 m0, s87, 66560
  s_add_u32 s71, s71, 1024
  buffer_load_dwordx4 v20, s[44:47], s71 offen sc1 lds
  s_add_u32 s69, s78, 3
  s_and_b32 s69, s69, 15
  s_lshr_b32 s68, s69, 2
  s_mul_i32 s68, s68, 7
  s_and_b32 s69, s69, 3
  s_add_u32 s68, s68, s69
  s_cmp_ge_u32 s69, 2
  s_cselect_b32 s69, 3, 0
  s_add_u32 s68, s68, s69
  s_mul_i32 s71, s68, 57344
  s_add_u32 s71, s71, s81
  s_add_u32 m0, s87, 106496
  s_nop 0
  buffer_load_dwordx4 v21, s[52:55], s71 offen lds
  s_add_u32 m0, s87, 107520
  s_add_u32 s71, s71, 7168
  buffer_load_dwordx4 v21, s[52:55], s71 offen lds
  s_barrier
  s_add_u32 s69, s78, 2
  s_and_b32 s69, s69, 15
  s_lshr_b32 s68, s69, 2
  s_mul_i32 s68, s68, 7
  s_and_b32 s69, s69, 3
  s_add_u32 s68, s68, s69
  s_cmp_ge_u32 s69, 2
  s_cselect_b32 s69, 3, 0
  s_add_u32 s68, s68, s69
  s_lshl_b32 s71, s68, 13
  s_add_u32 s71, s71, s79
  s_add_u32 m0, s87, 81920
  s_nop 0
  buffer_load_dwordx4 v20, s[44:47], s71 offen sc1 lds
  s_add_u32 m0, s87, 82944
  s_add_u32 s71, s71, 1024
  buffer_load_dwordx4 v20, s[44:47], s71 offen sc1 lds
  s_add_u32 s69, s78, 3
  s_and_b32 s69, s69, 15
  s_lshr_b32 s68, s69, 2
  s_mul_i32 s68, s68, 7
  s_and_b32 s69, s69, 3
  s_add_u32 s68, s68, s69
  s_cmp_ge_u32 s69, 2
  s_cselect_b32 s69, 3, 0
  s_add_u32 s68, s68, s69
  s_lshl_b32 s71, s68, 13
  s_add_u32 s71, s71, s79
  s_add_u32 m0, s87, 98304
  s_nop 0
  buffer_load_dwordx4 v20, s[44:47], s71 offen sc1 lds
  s_add_u32 m0, s87, 99328
  s_add_u32 s71, s71, 1024
  buffer_load_dwordx4 v20, s[44:47], s71 offen sc1 lds
  s_add_u32 s69, s78, 4
  s_and_b32 s69, s69, 15
  s_lshr_b32 s68, s69, 2
  s_mul_i32 s68, s68, 7
  s_and_b32 s69, s69, 3
  s_add_u32 s68, s68, s69
  s_cmp_ge_u32 s69, 2
  s_cselect_b32 s69, 3, 0
  s_add_u32 s68, s68, s69
  s_mul_i32 s71, s68, 57344
  s_add_u32 s71, s71, s81
  s_add_u32 m0, s87, 122880
  s_nop 0
  buffer_load_dwordx4 v21, s[52:55], s71 offen lds
  s_add_u32 m0, s87, 123904
  s_add_u32 s71, s71, 7168
  buffer_load_dwordx4 v21, s[52:55], s71 offen lds
  s_barrier
  s_add_u32 s69, s78, 4
  s_and_b32 s69, s69, 15
  s_lshr_b32 s68, s69, 2
  s_mul_i32 s68, s68, 7
  s_and_b32 s69, s69, 3
  s_add_u32 s68, s68, s69
  s_cmp_ge_u32 s69, 2
  s_cselect_b32 s69, 3, 0
  s_add_u32 s68, s68, s69
  s_lshl_b32 s71, s68, 13
  s_add_u32 s71, s71, s79
  s_add_u32 m0, s87, 114688
  s_nop 0
  buffer_load_dwordx4 v20, s[44:47], s71 offen sc1 lds
  s_add_u32 m0, s87, 115712
  s_add_u32 s71, s71, 1024
  buffer_load_dwordx4 v20, s[44:47], s71 offen sc1 lds
  s_add_u32 s69, s78, 5
  s_and_b32 s69, s69, 15
  s_lshr_b32 s68, s69, 2
  s_mul_i32 s68, s68, 7
  s_and_b32 s69, s69, 3
  s_add_u32 s68, s68, s69
  s_cmp_ge_u32 s69, 2
  s_cselect_b32 s69, 3, 0
  s_add_u32 s68, s68, s69
  s_mul_i32 s71, s68, 57344
  s_add_u32 s71, s71, s81
  s_add_u32 m0, s87, 139264
  s_nop 0
  buffer_load_dwordx4 v21, s[52:55], s71 offen lds
  s_add_u32 m0, s87, 140288
  s_add_u32 s71, s71, 7168
  buffer_load_dwordx4 v21, s[52:55], s71 offen lds
  s_waitcnt vmcnt(14)
  s_barrier
  s_add_u32 s69, s78, 5
  s_and_b32 s69, s69, 15
  s_lshr_b32 s68, s69, 2
  s_mul_i32 s68, s68, 7
  s_and_b32 s69, s69, 3
  s_add_u32 s68, s68, s69
  s_cmp_ge_u32 s69, 2
  s_cselect_b32 s69, 3, 0
  s_add_u32 s68, s68, s69
  s_lshl_b32 s71, s68, 13
  s_add_u32 s71, s71, s79
  s_add_u32 m0, s87, 131072
  s_nop 0
  buffer_load_dwordx4 v20, s[44:47], s71 offen sc1 lds
  s_add_u32 m0, s87, 132096
  s_add_u32 s71, s71, 1024
  buffer_load_dwordx4 v20, s[44:47], s71 offen sc1 lds
  s_add_u32 s69, s78, 6
  s_and_b32 s69, s69, 15
  s_lshr_b32 s68, s69, 2
  s_mul_i32 s68, s68, 7
  s_and_b32 s69, s69, 3
  s_add_u32 s68, s68, s69
  s_cmp_ge_u32 s69, 2
  s_cselect_b32 s69, 3, 0
  s_add_u32 s68, s68, s69
  s_mul_i32 s71, s68, 57344
  s_add_u32 s71, s71, s81
  s_add_u32 m0, s87, 8192
  s_nop 0
  buffer_load_dwordx4 v21, s[52:55], s71 offen lds
  s_add_u32 m0, s87, 9216
  s_add_u32 s71, s71, 7168
  buffer_load_dwordx4 v21, s[52:55], s71 offen lds
  s_waitcnt vmcnt(16)
  s_barrier
  s_add_u32 s69, s78, 6
  s_and_b32 s69, s69, 15
  s_lshr_b32 s68, s69, 2
  s_mul_i32 s68, s68, 7
  s_and_b32 s69, s69, 3
  s_add_u32 s68, s68, s69
  s_cmp_ge_u32 s69, 2
  s_cselect_b32 s69, 3, 0
  s_add_u32 s68, s68, s69
  s_lshl_b32 s71, s68, 13
  s_add_u32 s71, s71, s79
  s_add_u32 m0, s87, 0
  s_nop 0
  buffer_load_dwordx4 v20, s[44:47], s71 offen sc1 lds
  s_add_u32 m0, s87, 1024
  s_add_u32 s71, s71, 1024
  buffer_load_dwordx4 v20, s[44:47], s71 offen sc1 lds
  s_add_u32 s69, s78, 7
  s_and_b32 s69, s69, 15
  s_lshr_b32 s68, s69, 2
  s_mul_i32 s68, s68, 7
  s_and_b32 s69, s69, 3
  s_add_u32 s68, s68, s69
  s_cmp_ge_u32 s69, 2
  s_cselect_b32 s69, 3, 0
  s_add_u32 s68, s68, s69
  s_mul_i32 s71, s68, 57344
  s_add_u32 s71, s71, s81
  s_add_u32 m0, s87, 24576
  s_nop 0
  buffer_load_dwordx4 v21, s[52:55], s71 offen lds
  s_add_u32 m0, s87, 25600
  s_add_u32 s71, s71, 7168
  buffer_load_dwordx4 v21, s[52:55], s71 offen lds
  s_waitcnt vmcnt(16)
  s_barrier
  s_add_u32 s69, s78, 7
  s_and_b32 s69, s69, 15
  s_lshr_b32 s68, s69, 2
  s_mul_i32 s68, s68, 7
  s_and_b32 s69, s69, 3
  s_add_u32 s68, s68, s69
  s_cmp_ge_u32 s69, 2
  s_cselect_b32 s69, 3, 0
  s_add_u32 s68, s68, s69
  s_lshl_b32 s71, s68, 13
  s_add_u32 s71, s71, s79
  s_add_u32 m0, s87, 16384
  s_nop 0
  buffer_load_dwordx4 v20, s[44:47], s71 offen sc1 lds
  s_add_u32 m0, s87, 17408
  s_add_u32 s71, s71, 1024
  buffer_load_dwordx4 v20, s[44:47], s71 offen sc1 lds
  s_add_u32 s69, s78, 8
  s_and_b32 s69, s69, 15
  s_lshr_b32 s68, s69, 2
  s_mul_i32 s68, s68, 7
  s_and_b32 s69, s69, 3
  s_add_u32 s68, s68, s69
  s_cmp_ge_u32 s69, 2
  s_cselect_b32 s69, 3, 0
  s_add_u32 s68, s68, s69
  s_mul_i32 s71, s68, 57344
  s_add_u32 s71, s71, s81
  s_add_u32 m0, s87, 40960
  s_nop 0
  buffer_load_dwordx4 v21, s[52:55], s71 offen lds
  s_add_u32 m0, s87, 41984
  s_add_u32 s71, s71, 7168
  buffer_load_dwordx4 v21, s[52:55], s71 offen lds
  s_waitcnt vmcnt(18)
  s_barrier
  s_add_u32 s69, s78, 8
  s_and_b32 s69, s69, 15
  s_lshr_b32 s68, s69, 2
  s_mul_i32 s68, s68, 7
  s_and_b32 s69, s69, 3
  s_add_u32 s68, s68, s69
  s_cmp_ge_u32 s69, 2
  s_cselect_b32 s69, 3, 0
  s_add_u32 s68, s68, s69
  s_lshl_b32 s71, s68, 13
  s_add_u32 s71, s71, s79
  s_add_u32 m0, s87, 32768
  s_nop 0
  buffer_load_dwordx4 v20, s[44:47], s71 offen sc1 lds
  s_add_u32 m0, s87, 33792
  s_add_u32 s71, s71, 1024
  buffer_load_dwordx4 v20, s[44:47], s71 offen sc1 lds
  s_add_u32 s69, s78, 9
  s_and_b32 s69, s69, 15
  s_lshr_b32 s68, s69, 2
  s_mul_i32 s68, s68, 7
  s_and_b32 s69, s69, 3
  s_add_u32 s68, s68, s69
  s_cmp_ge_u32 s69, 2
  s_cselect_b32 s69, 3, 0
  s_add_u32 s68, s68, s69
  s_mul_i32 s71, s68, 57344
  s_add_u32 s71, s71, s81
  s_add_u32 m0, s87, 57344
  s_nop 0
  buffer_load_dwordx4 v21, s[52:55], s71 offen lds
  s_add_u32 m0, s87, 58368
  s_add_u32 s71, s71, 7168
  buffer_load_dwordx4 v21, s[52:55], s71 offen lds
  s_waitcnt vmcnt(18)
  s_barrier
  s_add_u32 s69, s78, 9
  s_and_b32 s69, s69, 15
  s_lshr_b32 s68, s69, 2
  s_mul_i32 s68, s68, 7
  s_and_b32 s69, s69, 3
  s_add_u32 s68, s68, s69
  s_cmp_ge_u32 s69, 2
  s_cselect_b32 s69, 3, 0
  s_add_u32 s68, s68, s69
  s_lshl_b32 s71, s68, 13
  s_add_u32 s71, s71, s79
  s_add_u32 m0, s87, 49152
  s_nop 0
  buffer_load_dwordx4 v20, s[44:47], s71 offen sc1 lds
  s_add_u32 m0, s87, 50176
  s_add_u32 s71, s71, 1024
  buffer_load_dwordx4 v20, s[44:47], s71 offen sc1 lds
  s_add_u32 s69, s78, 10
  s_and_b32 s69, s69, 15
  s_lshr_b32 s68, s69, 2
  s_mul_i32 s68, s68, 7
  s_and_b32 s69, s69, 3
  s_add_u32 s68, s68, s69
  s_cmp_ge_u32 s69, 2
  s_cselect_b32 s69, 3, 0
  s_add_u32 s68, s68, s69
  s_mul_i32 s71, s68, 57344
  s_add_u32 s71, s71, s81
  s_add_u32 m0, s87, 73728
  s_nop 0
  buffer_load_dwordx4 v21, s[52:55], s71 offen lds
  s_add_u32 m0, s87, 74752
  s_add_u32 s71, s71, 7168
  buffer_load_dwordx4 v21, s[52:55], s71 offen lds
  s_waitcnt vmcnt(18)
  s_barrier
  s_add_u32 s69, s78, 10
  s_and_b32 s69, s69, 15
  s_lshr_b32 s68, s69, 2
  s_mul_i32 s68, s68, 7
  s_and_b32 s69, s69, 3
  s_add_u32 s68, s68, s69
  s_cmp_ge_u32 s69, 2
  s_cselect_b32 s69, 3, 0
  s_add_u32 s68, s68, s69
  s_lshl_b32 s71, s68, 13
  s_add_u32 s71, s71, s79
  s_add_u32 m0, s87, 65536
  s_nop 0
  buffer_load_dwordx4 v20, s[44:47], s71 offen sc1 lds
  s_add_u32 m0, s87, 66560
  s_add_u32 s71, s71, 1024
  buffer_load_dwordx4 v20, s[44:47], s71 offen sc1 lds
  s_add_u32 s69, s78, 11
  s_and_b32 s69, s69, 15
  s_lshr_b32 s68, s69, 2
  s_mul_i32 s68, s68, 7
  s_and_b32 s69, s69, 3
  s_add_u32 s68, s68, s69
  s_cmp_ge_u32 s69, 2
  s_cselect_b32 s69, 3, 0
  s_add_u32 s68, s68, s69
  s_mul_i32 s71, s68, 57344
  s_add_u32 s71, s71, s81
  s_add_u32 m0, s87, 90112
  s_nop 0
  buffer_load_dwordx4 v21, s[52:55], s71 offen lds
  s_add_u32 m0, s87, 91136
  s_add_u32 s71, s71, 7168
  buffer_load_dwordx4 v21, s[52:55], s71 offen lds
  s_waitcnt vmcnt(18)
  s_barrier
  s_add_u32 s69, s78, 11
  s_and_b32 s69, s69, 15
  s_lshr_b32 s68, s69, 2
  s_mul_i32 s68, s68, 7
  s_and_b32 s69, s69, 3
  s_add_u32 s68, s68, s69
  s_cmp_ge_u32 s69, 2
  s_cselect_b32 s69, 3, 0
  s_add_u32 s68, s68, s69
  s_lshl_b32 s71, s68, 13
  s_add_u32 s71, s71, s79
  s_add_u32 m0, s87, 81920
  s_nop 0
  buffer_load_dwordx4 v20, s[44:47], s71 offen sc1 lds
  s_add_u32 m0, s87, 82944
  s_add_u32 s71, s71, 1024
  buffer_load_dwordx4 v20, s[44:47], s71 offen sc1 lds
  s_add_u32 s69, s78, 12
  s_and_b32 s69, s69, 15
  s_lshr_b32 s68, s69, 2
  s_mul_i32 s68, s68, 7
  s_and_b32 s69, s69, 3
  s_add_u32 s68, s68, s69
  s_cmp_ge_u32 s69, 2
  s_cselect_b32 s69, 3, 0
  s_add_u32 s68, s68, s69
  s_mul_i32 s71, s68, 57344
  s_add_u32 s71, s71, s81
  s_add_u32 m0, s87, 106496
  s_nop 0
  buffer_load_dwordx4 v21, s[52:55], s71 offen lds
  s_add_u32 m0, s87, 107520
  s_add_u32 s71, s71, 7168
  buffer_load_dwordx4 v21, s[52:55], s71 offen lds
  s_waitcnt vmcnt(18)
  s_barrier
  s_add_u32 s69, s78, 12
  s_and_b32 s69, s69, 15
  s_lshr_b32 s68, s69, 2
  s_mul_i32 s68, s68, 7
  s_and_b32 s69, s69, 3
  s_add_u32 s68, s68, s69
  s_cmp_ge_u32 s69, 2
  s_cselect_b32 s69, 3, 0
  s_add_u32 s68, s68, s69
  s_lshl_b32 s71, s68, 13
  s_add_u32 s71, s71, s79
  s_add_u32 m0, s87, 98304
  s_nop 0
  buffer_load_dwordx4 v20, s[44:47], s71 offen sc1 lds
  s_add_u32 m0, s87, 99328
  s_add_u32 s71, s71, 1024
  buffer_load_dwordx4 v20, s[44:47], s71 offen sc1 lds
  s_add_u32 s69, s78, 13
  s_and_b32 s69, s69, 15
  s_lshr_b32 s68, s69, 2
  s_mul_i32 s68, s68, 7
  s_and_b32 s69, s69, 3
  s_add_u32 s68, s68, s69
  s_cmp_ge_u32 s69, 2
  s_cselect_b32 s69, 3, 0
  s_add_u32 s68, s68, s69
  s_mul_i32 s71, s68, 57344
  s_add_u32 s71, s71, s81
  s_add_u32 m0, s87, 122880
  s_nop 0
  buffer_load_dwordx4 v21, s[52:55], s71 offen lds
  s_add_u32 m0, s87, 123904
  s_add_u32 s71, s71, 7168
  buffer_load_dwordx4 v21, s[52:55], s71 offen lds
  s_waitcnt vmcnt(18)
  s_barrier
  s_add_u32 s69, s78, 13
  s_and_b32 s69, s69, 15
  s_lshr_b32 s68, s69, 2
  s_mul_i32 s68, s68, 7
  s_and_b32 s69, s69, 3
  s_add_u32 s68, s68, s69
  s_cmp_ge_u32 s69, 2
  s_cselect_b32 s69, 3, 0
  s_add_u32 s68, s68, s69
  s_lshl_b32 s71, s68, 13
  s_add_u32 s71, s71, s79
  s_add_u32 m0, s87, 114688
  s_nop 0
  buffer_load_dwordx4 v20, s[44:47], s71 offen sc1 lds
  s_add_u32 m0, s87, 115712
  s_add_u32 s71, s71, 1024
  buffer_load_dwordx4 v20, s[44:47], s71 offen sc1 lds
  s_add_u32 s69, s78, 14
  s_and_b32 s69, s69, 15
  s_lshr_b32 s68, s69, 2
  s_mul_i32 s68, s68, 7
  s_and_b32 s69, s69, 3
  s_add_u32 s68, s68, s69
  s_cmp_ge_u32 s69, 2
  s_cselect_b32 s69, 3, 0
  s_add_u32 s68, s68, s69
  s_mul_i32 s71, s68, 57344
  s_add_u32 s71, s71, s81
  s_add_u32 m0, s87, 139264
  s_nop 0
  buffer_load_dwordx4 v21, s[52:55], s71 offen lds
  s_add_u32 m0, s87, 140288
  s_add_u32 s71, s71, 7168
  buffer_load_dwordx4 v21, s[52:55], s71 offen lds
  s_waitcnt vmcnt(18)
  s_barrier
  buffer_load_dword v23, v24, s[44:47], s90 offen sc1
  s_add_u32 s69, s78, 14
  s_and_b32 s69, s69, 15
  s_lshr_b32 s68, s69, 2
  s_mul_i32 s68, s68, 7
  s_and_b32 s69, s69, 3
  s_add_u32 s68, s68, s69
  s_cmp_ge_u32 s69, 2
  s_cselect_b32 s69, 3, 0
  s_add_u32 s68, s68, s69
  s_lshl_b32 s71, s68, 13
  s_add_u32 s71, s71, s79
  s_add_u32 m0, s87, 131072
  s_nop 0
  buffer_load_dwordx4 v20, s[44:47], s71 offen sc1 lds
  s_add_u32 m0, s87, 132096
  s_add_u32 s71, s71, 1024
  buffer_load_dwordx4 v20, s[44:47], s71 offen sc1 lds
  s_add_u32 s69, s78, 15
  s_and_b32 s69, s69, 15
  s_lshr_b32 s68, s69, 2
  s_mul_i32 s68, s68, 7
  s_and_b32 s69, s69, 3
  s_add_u32 s68, s68, s69
  s_cmp_ge_u32 s69, 2
  s_cselect_b32 s69, 3, 0
  s_add_u32 s68, s68, s69
  s_mul_i32 s71, s68, 57344
  s_add_u32 s71, s71, s81
  s_add_u32 m0, s87, 8192
  s_nop 0
  buffer_load_dwordx4 v21, s[52:55], s71 offen lds
  s_add_u32 m0, s87, 9216
  s_add_u32 s71, s71, 7168
  buffer_load_dwordx4 v21, s[52:55], s71 offen lds
  s_waitcnt vmcnt(19)
  s_barrier
  s_add_u32 s69, s78, 15
  s_and_b32 s69, s69, 15
  s_lshr_b32 s68, s69, 2
  s_mul_i32 s68, s68, 7
  s_and_b32 s69, s69, 3
  s_add_u32 s68, s68, s69
  s_cmp_ge_u32 s69, 2
  s_cselect_b32 s69, 3, 0
  s_add_u32 s68, s68, s69
  s_lshl_b32 s71, s68, 13
  s_add_u32 s71, s71, s79
  s_add_u32 m0, s87, 0
  s_nop 0
  buffer_load_dwordx4 v20, s[44:47], s71 offen sc1 lds
  s_add_u32 m0, s87, 1024
  s_add_u32 s71, s71, 1024
  buffer_load_dwordx4 v20, s[44:47], s71 offen sc1 lds
  s_add_u32 s68, s86, 0
  s_and_b32 s68, s68, 7
  s_mul_i32 s71, s68, 50176
  s_add_u32 s71, s71, s81
  s_add_u32 m0, s87, 24576
  s_nop 0
  buffer_load_dwordx4 v21, s[56:59], s71 offen lds
  s_add_u32 m0, s87, 25600
  s_add_u32 s71, s71, 7168
  buffer_load_dwordx4 v21, s[56:59], s71 offen lds
  s_waitcnt vmcnt(19)
  s_barrier
  s_waitcnt vmcnt(8)
  v_cmp_ne_u32 vcc, s74, v23
  s_cbranch_vccz Lok_16
  s_mov_b32 s95, 0x8000
Lpoll_17:
  buffer_load_dword v23, v24, s[44:47], s90 offen sc1
  s_waitcnt vmcnt(0)
  v_cmp_ne_u32 vcc, s74, v23
  s_cbranch_vccz Lpdone_18
  s_sleep 1
  s_sub_u32 s95, s95, 1
  s_cmp_lg_u32 s95, 0
  s_cbranch_scc1 Lpoll_17
Lpdone_18:
Lok_16:
  s_add_u32 s68, s86, 0
  s_and_b32 s68, s68, 7
  s_lshl_b32 s71, s68, 13
  s_add_u32 s71, s71, s80
  s_add_u32 m0, s87, 16384
  s_nop 0
  buffer_load_dwordx4 v20, s[44:47], s71 offen sc1 lds
  s_add_u32 m0, s87, 17408
  s_add_u32 s71, s71, 1024
  buffer_load_dwordx4 v20, s[44:47], s71 offen sc1 lds
  s_add_u32 s68, s86, 1
  s_and_b32 s68, s68, 7
  s_mul_i32 s71, s68, 50176
  s_add_u32 s71, s71, s81
  s_add_u32 m0, s87, 40960
  s_nop 0
  buffer_load_dwordx4 v21, s[56:59], s71 offen lds
  s_add_u32 m0, s87, 41984
  s_add_u32 s71, s71, 7168
  buffer_load_dwordx4 v21, s[56:59], s71 offen lds
  s_barrier
  s_add_u32 s68, s86, 1
  s_and_b32 s68, s68, 7
  s_lshl_b32 s71, s68, 13
  s_add_u32 s71, s71, s80
  s_add_u32 m0, s87, 32768
  s_nop 0
  buffer_load_dwordx4 v20, s[44:47], s71 offen sc1 lds
  s_add_u32 m0, s87, 33792
  s_add_u32 s71, s71, 1024
  buffer_load_dwordx4 v20, s[44:47], s71 offen sc1 lds
  s_add_u32 s68, s86, 2
  s_and_b32 s68, s68, 7
  s_mul_i32 s71, s68, 50176
  s_add_u32 s71, s71, s81
  s_add_u32 m0, s87, 57344
  s_nop 0
  buffer_load_dwordx4 v21, s[56:59], s71 offen lds
  s_add_u32 m0, s87, 58368
  s_add_u32 s71, s71, 7168
  buffer_load_dwordx4 v21, s[56:59], s71 offen lds
  s_barrier
  s_add_u32 s68, s86, 2
  s_and_b32 s68, s68, 7
  s_lshl_b32 s71, s68, 13
  s_add_u32 s71, s71, s80
  s_add_u32 m0, s87, 49152
  s_nop 0
  buffer_load_dwordx4 v20, s[44:47], s71 offen sc1 lds
  s_add_u32 m0, s87, 50176
  s_add_u32 s71, s71, 1024
  buffer_load_dwordx4 v20, s[44:47], s71 offen sc1 lds
  s_add_u32 s68, s86, 3
  s_and_b32 s68, s68, 7
  s_mul_i32 s71, s68, 50176
  s_add_u32 s71, s71, s81
  s_add_u32 m0, s87, 73728
  s_nop 0
  buffer_load_dwordx4 v21, s[56:59], s71 offen lds
  s_add_u32 m0, s87, 74752
  s_add_u32 s71, s71, 7168
  buffer_load_dwordx4 v21, s[56:59], s71 offen lds
  s_waitcnt vmcnt(18)
  s_barrier
  s_add_u32 s68, s86, 3
  s_and_b32 s68, s68, 7
  s_lshl_b32 s71, s68, 13
  s_add_u32 s71, s71, s80
  s_add_u32 m0, s87, 65536
  s_nop 0
  buffer_load_dwordx4 v20, s[44:47], s71 offen sc1 lds
  s_add_u32 m0, s87, 66560
  s_add_u32 s71, s71, 1024
  buffer_load_dwordx4 v20, s[44:47], s71 offen sc1 lds
  s_add_u32 s68, s86, 4
  s_and_b32 s68, s68, 7
  s_mul_i32 s71, s68, 50176
  s_add_u32 s71, s71, s81
  s_add_u32 m0, s87, 90112
  s_nop 0
  buffer_load_dwordx4 v21, s[56:59], s71 offen lds
  s_add_u32 m0, s87, 91136
  s_add_u32 s71, s71, 7168
  buffer_load_dwordx4 v21, s[56:59], s71 offen lds
  s_waitcnt vmcnt(18)
  s_barrier
  s_add_u32 s68, s86, 4
  s_and_b32 s68, s68, 7
  s_lshl_b32 s71, s68, 13
  s_add_u32 s71, s71, s80
  s_add_u32 m0, s87, 81920
  s_nop 0
  buffer_load_dwordx4 v20, s[44:47], s71 offen sc1 lds
  s_add_u32 m0, s87, 82944
  s_add_u32 s71, s71, 1024
  buffer_load_dwordx4 v20, s[44:47], s71 offen sc1 lds
  s_add_u32 s68, s86, 5
  s_and_b32 s68, s68, 7
  s_mul_i32 s71, s68, 50176
  s_add_u32 s71, s71, s81
  s_add_u32 m0, s87, 106496
  s_nop 0
  buffer_load_dwordx4 v21, s[56:59], s71 offen lds
  s_add_u32 m0, s87, 107520
  s_add_u32 s71, s71, 7168
  buffer_load_dwordx4 v21, s[56:59], s71 offen lds
  s_waitcnt vmcnt(18)
  s_barrier
  s_add_u32 s68, s86, 5
  s_and_b32 s68, s68, 7
  s_lshl_b32 s71, s68, 13
  s_add_u32 s71, s71, s80
  s_add_u32 m0, s87, 98304
  s_nop 0
  buffer_load_dwordx4 v20, s[44:47], s71 offen sc1 lds
  s_add_u32 m0, s87, 99328
  s_add_u32 s71, s71, 1024
  buffer_load_dwordx4 v20, s[44:47], s71 offen sc1 lds
  s_add_u32 s68, s86, 6
  s_and_b32 s68, s68, 7
  s_mul_i32 s71, s68, 50176
  s_add_u32 s71, s71, s81
  s_add_u32 m0, s87, 122880
  s_nop 0
  buffer_load_dwordx4 v21, s[56:59], s71 offen lds
  s_add_u32 m0, s87, 123904
  s_add_u32 s71, s71, 7168
  buffer_load_dwordx4 v21, s[56:59], s71 offen lds
  s_waitcnt vmcnt(18)
  s_barrier
  s_add_u32 s68, s86, 6
  s_and_b32 s68, s68, 7
  s_lshl_b32 s71, s68, 13
  s_add_u32 s71, s71, s80
  s_add_u32 m0, s87, 114688
  s_nop 0
  buffer_load_dwordx4 v20, s[44:47], s71 offen sc1 lds
  s_add_u32 m0, s87, 115712
  s_add_u32 s71, s71, 1024
  buffer_load_dwordx4 v20, s[44:47], s71 offen sc1 lds
  s_add_u32 s68, s86, 7
  s_and_b32 s68, s68, 7
  s_mul_i32 s71, s68, 50176
  s_add_u32 s71, s71, s81
  s_add_u32 m0, s87, 139264
  s_nop 0
  buffer_load_dwordx4 v21, s[56:59], s71 offen lds
  s_add_u32 m0, s87, 140288
  s_add_u32 s71, s71, 7168
  buffer_load_dwordx4 v21, s[56:59], s71 offen lds
  s_waitcnt vmcnt(18)
  s_barrier
  s_add_u32 s68, s86, 7
  s_and_b32 s68, s68, 7
  s_lshl_b32 s71, s68, 13
  s_add_u32 s71, s71, s80
  s_add_u32 m0, s87, 131072
  s_nop 0
  buffer_load_dwordx4 v20, s[44:47], s71 offen sc1 lds
  s_add_u32 m0, s87, 132096
  s_add_u32 s71, s71, 1024
  buffer_load_dwordx4 v20, s[44:47], s71 offen sc1 lds
  s_waitcnt vmcnt(16)
  s_barrier
  s_waitcnt vmcnt(12)
  s_barrier
  s_waitcnt vmcnt(8)
  s_barrier
  s_waitcnt vmcnt(4)
  s_barrier
  s_waitcnt vmcnt(0)
  s_barrier
  s_barrier
  s_barrier
  s_endpgm
L_consF:
  s_and_b32 s60, s29, 1
  s_lshr_b32 s61, s29, 1
  s_lshl_b32 s35, s29, 5
  v_bfe_u32 v7, v2, 1, 3
  v_add_u32 v8, s35, v2
  v_lshlrev_b32 v8, 7, v8
  v_or_b32 v9, 0, v3
  v_xor_b32 v9, v9, v7
  v_lshl_add_u32 v10, v9, 4, v8
  v_or_b32 v9, 2, v3
  v_xor_b32 v9, v9, v7
  v_lshl_add_u32 v11, v9, 4, v8
  v_or_b32 v9, 4, v3
  v_xor_b32 v9, v9, v7
  v_lshl_add_u32 v12, v9, 4, v8
  v_or_b32 v9, 6, v3
  v_xor_b32 v9, v9, v7
  v_lshl_add_u32 v13, v9, 4, v8
  s_lshl_b32 s67, s60, 6
  s_sub_u32 s67, s67, s35
  s_lshl_b32 s67, s67, 7
  v_lshl_add_u32 v7, v3, 3, v5
  v_lshlrev_b32 v8, 5, v4
  v_lshl_add_u32 v8, v6, 3, v8
  v_lshl_add_u32 v9, v7, 8, v8
  v_add_u32 v9, 114688, v9
  v_xor_b32 v21, 0, v5
  v_lshl_add_u32 v14, v21, 6, v9
  v_xor_b32 v21, 1, v5
  v_lshl_add_u32 v15, v21, 6, v9
  v_xor_b32 v21, 2, v5
  v_lshl_add_u32 v16, v21, 6, v9
  s_lshl_b32 s35, s61, 1
  v_xor_b32 v21, s35, v5
  v_lshl_add_u32 v19, v21, 6, v9
  v_xor_b32 v21, s35, v5
  v_xor_b32 v21, 1, v21
  v_lshl_add_u32 v20, v21, 6, v9
  v_lshlrev_b32 v7, 4, v2
  v_lshl_add_u32 v17, v3, 10, v7
  s_lshl_b32 s35, s30, 1
  s_add_u32 s35, s35, s61
  s_mul_i32 s64, s35, 229376
  s_lshl_b32 s35, s62, 7
  s_add_u32 s64, s64, s35
  s_lshl_b32 s35, s60, 9
  s_add_u32 s64, s64, s35
  s_add_u32 s64, s64, 5242880
  s_lshl_b32 s35, s30, 1
  s_add_u32 s35, s35, s60
  s_mul_i32 s65, s35, 229376
  s_lshl_b32 s35, s63, 7
  s_add_u32 s65, s65, s35
  s_lshl_b32 s35, s61, 13
  s_add_u32 s65, s65, s35
  s_add_u32 s65, s65, 5242880
  s_add_u32 s66, s65, 4096
  s_lshl_b32 s81, s30, 7
  s_lshl_b32 s35, s31, 2
  s_add_u32 s81, s81, s35
  s_add_u32 s82, s81, 2048
  s_waitcnt vmcnt(0)
  s_mul_i32 s68, s31, 224
  s_sub_u32 s69, s62, s68
  v_lshlrev_b32 v7, 2, v3
  v_add_u32 v8, s69, v7
  s_sub_u32 s69, s63, s68
  s_lshl_b32 s35, s61, 6
  s_add_u32 s69, s69, s35
  v_add_u32 v9, s69, v7
  ds_bpermute_b32 v192, v9, v184 offset:0
  ds_bpermute_b32 v193, v9, v185 offset:0
  ds_bpermute_b32 v194, v9, v184 offset:8
  ds_bpermute_b32 v195, v9, v185 offset:8
  ds_bpermute_b32 v196, v9, v184 offset:16
  ds_bpermute_b32 v197, v9, v185 offset:16
  ds_bpermute_b32 v198, v9, v184 offset:24
  ds_bpermute_b32 v199, v9, v185 offset:24
  s_waitcnt lgkmcnt(0)
  ds_bpermute_b32 v200, v9, v184 offset:32
  ds_bpermute_b32 v201, v9, v185 offset:32
  ds_bpermute_b32 v202, v9, v184 offset:40
  ds_bpermute_b32 v203, v9, v185 offset:40
  ds_bpermute_b32 v204, v9, v184 offset:48
  ds_bpermute_b32 v205, v9, v185 offset:48
  ds_bpermute_b32 v206, v9, v184 offset:56
  ds_bpermute_b32 v207, v9, v185 offset:56
  s_waitcnt lgkmcnt(0)
  ds_bpermute_b32 v24, v8, v184 offset:0
  ds_bpermute_b32 v25, v8, v185 offset:0
  ds_bpermute_b32 v26, v8, v184 offset:8
  ds_bpermute_b32 v27, v8, v185 offset:8
  ds_bpermute_b32 v28, v8, v184 offset:16
  ds_bpermute_b32 v29, v8, v185 offset:16
  ds_bpermute_b32 v30, v8, v184 offset:24
  ds_bpermute_b32 v31, v8, v185 offset:24
  s_waitcnt lgkmcnt(0)
  v_lshlrev_b32 v128, 16, v24
  v_and_b32 v129, 0xffff0000, v24
  v_lshlrev_b32 v130, 16, v25
  v_and_b32 v131, 0xffff0000, v25
  v_lshlrev_b32 v132, 16, v26
  v_and_b32 v133, 0xffff0000, v26
  v_lshlrev_b32 v134, 16, v27
  v_and_b32 v135, 0xffff0000, v27
  v_lshlrev_b32 v136, 16, v28
  v_and_b32 v137, 0xffff0000, v28
  v_lshlrev_b32 v138, 16, v29
  v_and_b32 v139, 0xffff0000, v29
  v_lshlrev_b32 v140, 16, v30
  v_and_b32 v141, 0xffff0000, v30
  v_lshlrev_b32 v142, 16, v31
  v_and_b32 v143, 0xffff0000, v31
  ds_bpermute_b32 v32, v8, v184 offset:32
  ds_bpermute_b32 v33, v8, v185 offset:32
  ds_bpermute_b32 v34, v8, v184 offset:40
  ds_bpermute_b32 v35, v8, v185 offset:40
  ds_bpermute_b32 v36, v8, v184 offset:48
  ds_bpermute_b32 v37, v8, v185 offset:48
  ds_bpermute_b32 v38, v8, v184 offset:56
  ds_bpermute_b32 v39, v8, v185 offset:56
  s_waitcnt lgkmcnt(0)
  v_lshlrev_b32 v144, 16, v32
  v_and_b32 v145, 0xffff0000, v32
  v_lshlrev_b32 v146, 16, v33
  v_and_b32 v147, 0xffff0000, v33
  v_lshlrev_b32 v148, 16, v34
  v_and_b32 v149, 0xffff0000, v34
  v_lshlrev_b32 v150, 16, v35
  v_and_b32 v151, 0xffff0000, v35
  v_lshlrev_b32 v152, 16, v36
  v_and_b32 v153, 0xffff0000, v36
  v_lshlrev_b32 v154, 16, v37
  v_and_b32 v155, 0xffff0000, v37
  v_lshlrev_b32 v156, 16, v38
  v_and_b32 v157, 0xffff0000, v38
  v_lshlrev_b32 v158, 16, v39
  v_and_b32 v159, 0xffff0000, v39
  ds_bpermute_b32 v40, v8, v184 offset:64
  ds_bpermute_b32 v41, v8, v185 offset:64
  ds_bpermute_b32 v42, v8, v184 offset:72
  ds_bpermute_b32 v43, v8, v185 offset:72
  ds_bpermute_b32 v44, v8, v184 offset:80
  ds_bpermute_b32 v45, v8, v185 offset:80
  ds_bpermute_b32 v46, v8, v184 offset:88
  ds_bpermute_b32 v47, v8, v185 offset:88
  s_waitcnt lgkmcnt(0)
  v_lshlrev_b32 v160, 16, v40
  v_and_b32 v161, 0xffff0000, v40
  v_lshlrev_b32 v162, 16, v41
  v_and_b32 v163, 0xffff0000, v41
  v_lshlrev_b32 v164, 16, v42
  v_and_b32 v165, 0xffff0000, v42
  v_lshlrev_b32 v166, 16, v43
  v_and_b32 v167, 0xffff0000, v43
  v_lshlrev_b32 v168, 16, v44
  v_and_b32 v169, 0xffff0000, v44
  v_lshlrev_b32 v170, 16, v45
  v_and_b32 v171, 0xffff0000, v45
  v_lshlrev_b32 v172, 16, v46
  v_and_b32 v173, 0xffff0000, v46
  v_lshlrev_b32 v174, 16, v47
  v_and_b32 v175, 0xffff0000, v47
  s_waitcnt lgkmcnt(0)
  s_mul_i32 s74, s74, 0x9E3779B1
  s_add_u32 s74, s74, 0x7F4A7C15
  s_barrier
  ds_read_b128 v[24:27], v10 offset:0
  ds_read_b64_tr_b16 v[28:29], v14 offset:0
  ds_read_b64_tr_b16 v[30:31], v14 offset:1024
  ds_read_b64_tr_b16 v[32:33], v15 offset:0
  ds_read_b64_tr_b16 v[34:35], v15 offset:1024
  ds_read_b64_tr_b16 v[36:37], v16 offset:0
  ds_read_b64_tr_b16 v[38:39], v16 offset:1024
  s_waitcnt lgkmcnt(4)
  v_mfma_f32_32x32x16_bf16 v[128:143], v[28:31], v[24:27], v[128:143]
  ds_read_b128 v[40:43], v11 offset:0
  ds_read_b64_tr_b16 v[44:45], v14 offset:4096
  ds_read_b64_tr_b16 v[46:47], v14 offset:5120
  ds_read_b64_tr_b16 v[48:49], v15 offset:4096
  v_lshlrev_b32 v64, 16, v192
  v_and_b32 v65, 0xffff0000, v192
  s_waitcnt lgkmcnt(6)
  v_mfma_f32_32x32x16_bf16 v[144:159], v[32:35], v[24:27], v[144:159]
  ds_read_b64_tr_b16 v[50:51], v15 offset:5120
  ds_read_b64_tr_b16 v[52:53], v16 offset:4096
  ds_read_b64_tr_b16 v[54:55], v16 offset:5120
  v_lshlrev_b32 v66, 16, v193
  v_and_b32 v67, 0xffff0000, v193
  s_waitcnt lgkmcnt(7)
  v_mfma_f32_32x32x16_bf16 v[160:175], v[36:39], v[24:27], v[160:175]
  v_lshlrev_b32 v80, 16, v192
  v_and_b32 v81, 0xffff0000, v192
  s_waitcnt lgkmcnt(4)
  v_mfma_f32_32x32x16_bf16 v[128:143], v[44:47], v[40:43], v[128:143]
  ds_read_b128 v[24:27], v12 offset:0
  ds_read_b64_tr_b16 v[28:29], v14 offset:8192
  ds_read_b64_tr_b16 v[30:31], v14 offset:9216
  ds_read_b64_tr_b16 v[32:33], v15 offset:8192
  v_lshlrev_b32 v82, 16, v193
  v_and_b32 v83, 0xffff0000, v193
  s_waitcnt lgkmcnt(6)
  v_mfma_f32_32x32x16_bf16 v[144:159], v[48:51], v[40:43], v[144:159]
  ds_read_b64_tr_b16 v[34:35], v15 offset:9216
  ds_read_b64_tr_b16 v[36:37], v16 offset:8192
  ds_read_b64_tr_b16 v[38:39], v16 offset:9216
  v_lshlrev_b32 v68, 16, v194
  v_and_b32 v69, 0xffff0000, v194
  s_waitcnt lgkmcnt(7)
  v_mfma_f32_32x32x16_bf16 v[160:175], v[52:55], v[40:43], v[160:175]
  v_lshlrev_b32 v70, 16, v195
  v_and_b32 v71, 0xffff0000, v195
  s_waitcnt lgkmcnt(4)
  v_mfma_f32_32x32x16_bf16 v[128:143], v[28:31], v[24:27], v[128:143]
  ds_read_b128 v[40:43], v13 offset:0
  ds_read_b64_tr_b16 v[44:45], v14 offset:12288
  ds_read_b64_tr_b16 v[46:47], v14 offset:13312
  ds_read_b64_tr_b16 v[48:49], v15 offset:12288
  v_lshlrev_b32 v84, 16, v194
  v_and_b32 v85, 0xffff0000, v194
  s_waitcnt lgkmcnt(6)
  v_mfma_f32_32x32x16_bf16 v[144:159], v[32:35], v[24:27], v[144:159]
  ds_read_b64_tr_b16 v[50:51], v15 offset:13312
  ds_read_b64_tr_b16 v[52:53], v16 offset:12288
  ds_read_b64_tr_b16 v[54:55], v16 offset:13312
  v_lshlrev_b32 v86, 16, v195
  v_and_b32 v87, 0xffff0000, v195
  s_waitcnt lgkmcnt(7)
  v_mfma_f32_32x32x16_bf16 v[160:175], v[36:39], v[24:27], v[160:175]
  v_lshlrev_b32 v72, 16, v196
  v_and_b32 v73, 0xffff0000, v196
  s_waitcnt lgkmcnt(4)
  v_mfma_f32_32x32x16_bf16 v[128:143], v[44:47], v[40:43], v[128:143]
  s_waitcnt lgkmcnt(0)
  s_barrier
  ds_read_b128 v[24:27], v10 offset:16384
  ds_read_b64_tr_b16 v[28:29], v14 offset:16384
  ds_read_b64_tr_b16 v[30:31], v14 offset:17408
  ds_read_b64_tr_b16 v[32:33], v15 offset:16384
  v_mfma_f32_32x32x16_bf16 v[144:159], v[48:51], v[40:43], v[144:159]
  ds_read_b64_tr_b16 v[34:35], v15 offset:17408
  ds_read_b64_tr_b16 v[36:37], v16 offset:16384
  ds_read_b64_tr_b16 v[38:39], v16 offset:17408
  v_lshlrev_b32 v74, 16, v197
  v_and_b32 v75, 0xffff0000, v197
  v_mfma_f32_32x32x16_bf16 v[160:175], v[52:55], v[40:43], v[160:175]
  v_lshlrev_b32 v88, 16, v196
  v_and_b32 v89, 0xffff0000, v196
  s_waitcnt lgkmcnt(4)
  v_mfma_f32_32x32x16_bf16 v[128:143], v[28:31], v[24:27], v[128:143]
  ds_read_b128 v[40:43], v11 offset:16384
  ds_read_b64_tr_b16 v[44:45], v14 offset:20480
  ds_read_b64_tr_b16 v[46:47], v14 offset:21504
  ds_read_b64_tr_b16 v[48:49], v15 offset:20480
  v_lshlrev_b32 v90, 16, v197
  v_and_b32 v91, 0xffff0000, v197
  s_waitcnt lgkmcnt(6)
  v_mfma_f32_32x32x16_bf16 v[144:159], v[32:35], v[24:27], v[144:159]
  ds_read_b64_tr_b16 v[50:51], v15 offset:21504
  ds_read_b64_tr_b16 v[52:53], v16 offset:20480
  ds_read_b64_tr_b16 v[54:55], v16 offset:21504
  v_lshlrev_b32 v76, 16, v198
  v_and_b32 v77, 0xffff0000, v198
  s_waitcnt lgkmcnt(7)
  v_mfma_f32_32x32x16_bf16 v[160:175], v[36:39], v[24:27], v[160:175]
  v_lshlrev_b32 v78, 16, v199
  v_and_b32 v79, 0xffff0000, v199
  s_waitcnt lgkmcnt(4)
  v_mfma_f32_32x32x16_bf16 v[128:143], v[44:47], v[40:43], v[128:143]
  ds_read_b128 v[24:27], v12 offset:16384
  ds_read_b64_tr_b16 v[28:29], v14 offset:24576
  ds_read_b64_tr_b16 v[30:31], v14 offset:25600
  ds_read_b64_tr_b16 v[32:33], v15 offset:24576
  v_lshlrev_b32 v92, 16, v198
  v_and_b32 v93, 0xffff0000, v198
  s_waitcnt lgkmcnt(6)
  v_mfma_f32_32x32x16_bf16 v[144:159], v[48:51], v[40:43], v[144:159]
  ds_read_b64_tr_b16 v[34:35], v15 offset:25600
  ds_read_b64_tr_b16 v[36:37], v16 offset:24576
  ds_read_b64_tr_b16 v[38:39], v16 offset:25600
  v_lshlrev_b32 v94, 16, v199
  v_and_b32 v95, 0xffff0000, v199
  s_waitcnt lgkmcnt(7)
  v_mfma_f32_32x32x16_bf16 v[160:175], v[52:55], v[40:43], v[160:175]
  v_lshlrev_b32 v96, 16, v200
  v_and_b32 v97, 0xffff0000, v200
  s_waitcnt lgkmcnt(4)
  v_mfma_f32_32x32x16_bf16 v[128:143], v[28:31], v[24:27], v[128:143]
  ds_read_b128 v[40:43], v13 offset:16384
  ds_read_b64_tr_b16 v[44:45], v14 offset:28672
  ds_read_b64_tr_b16 v[46:47], v14 offset:29696
  ds_read_b64_tr_b16 v[48:49], v15 offset:28672
  v_lshlrev_b32 v98, 16, v201
  v_and_b32 v99, 0xffff0000, v201
  s_waitcnt lgkmcnt(6)
  v_mfma_f32_32x32x16_bf16 v[144:159], v[32:35], v[24:27], v[144:159]
  ds_read_b64_tr_b16 v[50:51], v15 offset:29696
  ds_read_b64_tr_b16 v[52:53], v16 offset:28672
  ds_read_b64_tr_b16 v[54:55], v16 offset:29696
  v_lshlrev_b32 v112, 16, v200
  v_and_b32 v113, 0xffff0000, v200
  s_waitcnt lgkmcnt(7)
  v_mfma_f32_32x32x16_bf16 v[160:175], v[36:39], v[24:27], v[160:175]
  v_lshlrev_b32 v114, 16, v201
  v_and_b32 v115, 0xffff0000, v201
  s_waitcnt lgkmcnt(4)
  v_mfma_f32_32x32x16_bf16 v[128:143], v[44:47], v[40:43], v[128:143]
  s_waitcnt lgkmcnt(0)
  s_barrier
  ds_read_b128 v[24:27], v10 offset:32768
  ds_read_b64_tr_b16 v[28:29], v14 offset:32768
  ds_read_b64_tr_b16 v[30:31], v14 offset:33792
  ds_read_b64_tr_b16 v[32:33], v15 offset:32768
  v_mfma_f32_32x32x16_bf16 v[144:159], v[48:51], v[40:43], v[144:159]
  ds_read_b64_tr_b16 v[34:35], v15 offset:33792
  ds_read_b64_tr_b16 v[36:37], v16 offset:32768
  ds_read_b64_tr_b16 v[38:39], v16 offset:33792
  v_lshlrev_b32 v100, 16, v202
  v_and_b32 v101, 0xffff0000, v202
  v_mfma_f32_32x32x16_bf16 v[160:175], v[52:55], v[40:43], v[160:175]
  v_lshlrev_b32 v102, 16, v203
  v_and_b32 v103, 0xffff0000, v203
  s_waitcnt lgkmcnt(4)
  v_mfma_f32_32x32x16_bf16 v[128:143], v[28:31], v[24:27], v[128:143]
  ds_read_b128 v[40:43], v11 offset:32768
  ds_read_b64_tr_b16 v[44:45], v14 offset:36864
  ds_read_b64_tr_b16 v[46:47], v14 offset:37888
  ds_read_b64_tr_b16 v[48:49], v15 offset:36864
  v_lshlrev_b32 v116, 16, v202
  v_and_b32 v117, 0xffff0000, v202
  s_waitcnt lgkmcnt(6)
  v_mfma_f32_32x32x16_bf16 v[144:159], v[32:35], v[24:27], v[144:159]
  ds_read_b64_tr_b16 v[50:51], v15 offset:37888
  ds_read_b64_tr_b16 v[52:53], v16 offset:36864
  ds_read_b64_tr_b16 v[54:55], v16 offset:37888
  v_lshlrev_b32 v118, 16, v203
  v_and_b32 v119, 0xffff0000, v203
  s_waitcnt lgkmcnt(7)
  v_mfma_f32_32x32x16_bf16 v[160:175], v[36:39], v[24:27], v[160:175]
  v_lshlrev_b32 v104, 16, v204
  v_and_b32 v105, 0xffff0000, v204
  s_waitcnt lgkmcnt(4)
  v_mfma_f32_32x32x16_bf16 v[128:143], v[44:47], v[40:43], v[128:143]
  ds_read_b128 v[24:27], v12 offset:32768
  ds_read_b64_tr_b16 v[28:29], v14 offset:40960
  ds_read_b64_tr_b16 v[30:31], v14 offset:41984
  ds_read_b64_tr_b16 v[32:33], v15 offset:40960
  v_lshlrev_b32 v106, 16, v205
  v_and_b32 v107, 0xffff0000, v205
  s_waitcnt lgkmcnt(6)
  v_mfma_f32_32x32x16_bf16 v[144:159], v[48:51], v[40:43], v[144:159]
  ds_read_b64_tr_b16 v[34:35], v15 offset:41984
  ds_read_b64_tr_b16 v[36:37], v16 offset:40960
  ds_read_b64_tr_b16 v[38:39], v16 offset:41984
  v_lshlrev_b32 v120, 16, v204
  v_and_b32 v121, 0xffff0000, v204
  s_waitcnt lgkmcnt(7)
  v_mfma_f32_32x32x16_bf16 v[160:175], v[52:55], v[40:43], v[160:175]
  v_lshlrev_b32 v122, 16, v205
  v_and_b32 v123, 0xffff0000, v205
  s_waitcnt lgkmcnt(4)
  v_mfma_f32_32x32x16_bf16 v[128:143], v[28:31], v[24:27], v[128:143]
  ds_read_b128 v[40:43], v13 offset:32768
  ds_read_b64_tr_b16 v[44:45], v14 offset:45056
  ds_read_b64_tr_b16 v[46:47], v14 offset:46080
  ds_read_b64_tr_b16 v[48:49], v15 offset:45056
  v_lshlrev_b32 v108, 16, v206
  v_and_b32 v109, 0xffff0000, v206
  s_waitcnt lgkmcnt(6)
  v_mfma_f32_32x32x16_bf16 v[144:159], v[32:35], v[24:27], v[144:159]
  ds_read_b64_tr_b16 v[50:51], v15 offset:46080
  ds_read_b64_tr_b16 v[52:53], v16 offset:45056
  ds_read_b64_tr_b16 v[54:55], v16 offset:46080
  v_lshlrev_b32 v110, 16, v207
  v_and_b32 v111, 0xffff0000, v207
  s_waitcnt lgkmcnt(7)
  v_mfma_f32_32x32x16_bf16 v[160:175], v[36:39], v[24:27], v[160:175]
  v_lshlrev_b32 v124, 16, v206
  v_and_b32 v125, 0xffff0000, v206
  s_waitcnt lgkmcnt(4)
  v_mfma_f32_32x32x16_bf16 v[128:143], v[44:47], v[40:43], v[128:143]
  s_waitcnt lgkmcnt(0)
  s_barrier
  ds_read_b128 v[24:27], v10 offset:49152
  ds_read_b64_tr_b16 v[28:29], v14 offset:0
  ds_read_b64_tr_b16 v[30:31], v14 offset:1024
  ds_read_b64_tr_b16 v[32:33], v15 offset:0
  v_mfma_f32_32x32x16_bf16 v[144:159], v[48:51], v[40:43], v[144:159]
  ds_read_b64_tr_b16 v[34:35], v15 offset:1024
  ds_read_b64_tr_b16 v[36:37], v16 offset:0
  ds_read_b64_tr_b16 v[38:39], v16 offset:1024
  v_lshlrev_b32 v126, 16, v207
  v_and_b32 v127, 0xffff0000, v207
  v_mfma_f32_32x32x16_bf16 v[160:175], v[52:55], v[40:43], v[160:175]
  s_waitcnt lgkmcnt(4)
  v_mfma_f32_32x32x16_bf16 v[128:143], v[28:31], v[24:27], v[128:143]
  ds_read_b128 v[40:43], v11 offset:49152
  ds_read_b64_tr_b16 v[44:45], v14 offset:4096
  ds_read_b64_tr_b16 v[46:47], v14 offset:5120
  ds_read_b64_tr_b16 v[48:49], v15 offset:4096
  s_waitcnt lgkmcnt(6)
  v_mfma_f32_32x32x16_bf16 v[144:159], v[32:35], v[24:27], v[144:159]
  ds_read_b64_tr_b16 v[50:51], v15 offset:5120
  ds_read_b64_tr_b16 v[52:53], v16 offset:4096
  ds_read_b64_tr_b16 v[54:55], v16 offset:5120
  s_waitcnt lgkmcnt(7)
  v_mfma_f32_32x32x16_bf16 v[160:175], v[36:39], v[24:27], v[160:175]
  s_waitcnt lgkmcnt(4)
  v_mfma_f32_32x32x16_bf16 v[128:143], v[44:47], v[40:43], v[128:143]
  ds_read_b128 v[24:27], v12 offset:49152
  ds_read_b64_tr_b16 v[28:29], v14 offset:8192
  ds_read_b64_tr_b16 v[30:31], v14 offset:9216
  ds_read_b64_tr_b16 v[32:33], v15 offset:8192
  s_waitcnt lgkmcnt(6)
  v_mfma_f32_32x32x16_bf16 v[144:159], v[48:51], v[40:43], v[144:159]
  ds_read_b64_tr_b16 v[34:35], v15 offset:9216
  ds_read_b64_tr_b16 v[36:37], v16 offset:8192
  ds_read_b64_tr_b16 v[38:39], v16 offset:9216
  s_waitcnt lgkmcnt(7)
  v_mfma_f32_32x32x16_bf16 v[160:175], v[52:55], v[40:43], v[160:175]
  s_waitcnt lgkmcnt(4)
  v_mfma_f32_32x32x16_bf16 v[128:143], v[28:31], v[24:27], v[128:143]
  ds_read_b128 v[40:43], v13 offset:49152
  ds_read_b64_tr_b16 v[44:45], v14 offset:12288
  ds_read_b64_tr_b16 v[46:47], v14 offset:13312
  ds_read_b64_tr_b16 v[48:49], v15 offset:12288
  s_waitcnt lgkmcnt(6)
  v_mfma_f32_32x32x16_bf16 v[144:159], v[32:35], v[24:27], v[144:159]
  ds_read_b64_tr_b16 v[50:51], v15 offset:13312
  ds_read_b64_tr_b16 v[52:53], v16 offset:12288
  ds_read_b64_tr_b16 v[54:55], v16 offset:13312
  s_waitcnt lgkmcnt(7)
  v_mfma_f32_32x32x16_bf16 v[160:175], v[36:39], v[24:27], v[160:175]
  s_waitcnt lgkmcnt(4)
  v_mfma_f32_32x32x16_bf16 v[128:143], v[44:47], v[40:43], v[128:143]
  s_waitcnt lgkmcnt(0)
  s_barrier
  v_add_u32 v10, 65536, v10
  v_add_u32 v11, 65536, v11
  v_add_u32 v12, 65536, v12
  v_add_u32 v13, 65536, v13
  ds_read_b128 v[24:27], v10 offset:0
  ds_read_b64_tr_b16 v[28:29], v14 offset:16384
  ds_read_b64_tr_b16 v[30:31], v14 offset:17408
  ds_read_b64_tr_b16 v[32:33], v15 offset:16384
  v_mfma_f32_32x32x16_bf16 v[144:159], v[48:51], v[40:43], v[144:159]
  ds_read_b64_tr_b16 v[34:35], v15 offset:17408
  ds_read_b64_tr_b16 v[36:37], v16 offset:16384
  ds_read_b64_tr_b16 v[38:39], v16 offset:17408
  v_mfma_f32_32x32x16_bf16 v[160:175], v[52:55], v[40:43], v[160:175]
  s_waitcnt lgkmcnt(4)
  v_mfma_f32_32x32x16_bf16 v[128:143], v[28:31], v[24:27], v[128:143]
  ds_read_b128 v[40:43], v11 offset:0
  ds_read_b64_tr_b16 v[44:45], v14 offset:20480
  ds_read_b64_tr_b16 v[46:47], v14 offset:21504
  ds_read_b64_tr_b16 v[48:49], v15 offset:20480
  s_waitcnt lgkmcnt(6)
  v_mfma_f32_32x32x16_bf16 v[144:159], v[32:35], v[24:27], v[144:159]
  ds_read_b64_tr_b16 v[50:51], v15 offset:21504
  ds_read_b64_tr_b16 v[52:53], v16 offset:20480
  ds_read_b64_tr_b16 v[54:55], v16 offset:21504
  s_waitcnt lgkmcnt(7)
  v_mfma_f32_32x32x16_bf16 v[160:175], v[36:39], v[24:27], v[160:175]
  s_waitcnt lgkmcnt(4)
  v_mfma_f32_32x32x16_bf16 v[128:143], v[44:47], v[40:43], v[128:143]
  ds_read_b128 v[24:27], v12 offset:0
  ds_read_b64_tr_b16 v[28:29], v14 offset:24576
  ds_read_b64_tr_b16 v[30:31], v14 offset:25600
  ds_read_b64_tr_b16 v[32:33], v15 offset:24576
  s_waitcnt lgkmcnt(6)
  v_mfma_f32_32x32x16_bf16 v[144:159], v[48:51], v[40:43], v[144:159]
  ds_read_b64_tr_b16 v[34:35], v15 offset:25600
  ds_read_b64_tr_b16 v[36:37], v16 offset:24576
  ds_read_b64_tr_b16 v[38:39], v16 offset:25600
  s_waitcnt lgkmcnt(7)
  v_mfma_f32_32x32x16_bf16 v[160:175], v[52:55], v[40:43], v[160:175]
  s_waitcnt lgkmcnt(4)
  v_mfma_f32_32x32x16_bf16 v[128:143], v[28:31], v[24:27], v[128:143]
  ds_read_b128 v[40:43], v13 offset:0
  ds_read_b64_tr_b16 v[44:45], v14 offset:28672
  ds_read_b64_tr_b16 v[46:47], v14 offset:29696
  ds_read_b64_tr_b16 v[48:49], v15 offset:28672
  s_waitcnt lgkmcnt(6)
  v_mfma_f32_32x32x16_bf16 v[144:159], v[32:35], v[24:27], v[144:159]
  ds_read_b64_tr_b16 v[50:51], v15 offset:29696
  ds_read_b64_tr_b16 v[52:53], v16 offset:28672
  ds_read_b64_tr_b16 v[54:55], v16 offset:29696
  s_waitcnt lgkmcnt(7)
  v_mfma_f32_32x32x16_bf16 v[160:175], v[36:39], v[24:27], v[160:175]
  s_waitcnt lgkmcnt(4)
  v_mfma_f32_32x32x16_bf16 v[128:143], v[44:47], v[40:43], v[128:143]
  s_waitcnt lgkmcnt(0)
  s_barrier
  ds_read_b128 v[24:27], v10 offset:16384
  ds_read_b64_tr_b16 v[28:29], v14 offset:32768
  ds_read_b64_tr_b16 v[30:31], v14 offset:33792
  ds_read_b64_tr_b16 v[32:33], v15 offset:32768
  v_mfma_f32_32x32x16_bf16 v[144:159], v[48:51], v[40:43], v[144:159]
  ds_read_b64_tr_b16 v[34:35], v15 offset:33792
  ds_read_b64_tr_b16 v[36:37], v16 offset:32768
  ds_read_b64_tr_b16 v[38:39], v16 offset:33792
  v_mfma_f32_32x32x16_bf16 v[160:175], v[52:55], v[40:43], v[160:175]
  s_waitcnt lgkmcnt(4)
  v_mfma_f32_32x32x16_bf16 v[128:143], v[28:31], v[24:27], v[128:143]
  ds_read_b128 v[40:43], v11 offset:16384
  ds_read_b64_tr_b16 v[44:45], v14 offset:36864
  ds_read_b64_tr_b16 v[46:47], v14 offset:37888
  ds_read_b64_tr_b16 v[48:49], v15 offset:36864
  s_waitcnt lgkmcnt(6)
  v_mfma_f32_32x32x16_bf16 v[144:159], v[32:35], v[24:27], v[144:159]
  ds_read_b64_tr_b16 v[50:51], v15 offset:37888
  ds_read_b64_tr_b16 v[52:53], v16 offset:36864
  ds_read_b64_tr_b16 v[54:55], v16 offset:37888
  s_waitcnt lgkmcnt(7)
  v_mfma_f32_32x32x16_bf16 v[160:175], v[36:39], v[24:27], v[160:175]
  s_waitcnt lgkmcnt(4)
  v_mfma_f32_32x32x16_bf16 v[128:143], v[44:47], v[40:43], v[128:143]
  ds_read_b128 v[24:27], v12 offset:16384
  ds_read_b64_tr_b16 v[28:29], v14 offset:40960
  ds_read_b64_tr_b16 v[30:31], v14 offset:41984
  ds_read_b64_tr_b16 v[32:33], v15 offset:40960
  s_waitcnt lgkmcnt(6)
  v_mfma_f32_32x32x16_bf16 v[144:159], v[48:51], v[40:43], v[144:159]
  ds_read_b64_tr_b16 v[34:35], v15 offset:41984
  ds_read_b64_tr_b16 v[36:37], v16 offset:40960
  ds_read_b64_tr_b16 v[38:39], v16 offset:41984
  s_waitcnt lgkmcnt(7)
  v_mfma_f32_32x32x16_bf16 v[160:175], v[52:55], v[40:43], v[160:175]
  s_waitcnt lgkmcnt(4)
  v_mfma_f32_32x32x16_bf16 v[128:143], v[28:31], v[24:27], v[128:143]
  ds_read_b128 v[40:43], v13 offset:16384
  ds_read_b64_tr_b16 v[44:45], v14 offset:45056
  ds_read_b64_tr_b16 v[46:47], v14 offset:46080
  ds_read_b64_tr_b16 v[48:49], v15 offset:45056
  s_waitcnt lgkmcnt(6)
  v_mfma_f32_32x32x16_bf16 v[144:159], v[32:35], v[24:27], v[144:159]
  ds_read_b64_tr_b16 v[50:51], v15 offset:46080
  ds_read_b64_tr_b16 v[52:53], v16 offset:45056
  ds_read_b64_tr_b16 v[54:55], v16 offset:46080
  s_waitcnt lgkmcnt(7)
  v_mfma_f32_32x32x16_bf16 v[160:175], v[36:39], v[24:27], v[160:175]
  s_waitcnt lgkmcnt(4)
  v_mfma_f32_32x32x16_bf16 v[128:143], v[44:47], v[40:43], v[128:143]
  s_waitcnt lgkmcnt(0)
  s_barrier
  ds_read_b128 v[24:27], v10 offset:32768
  ds_read_b64_tr_b16 v[28:29], v14 offset:0
  ds_read_b64_tr_b16 v[30:31], v14 offset:1024
  ds_read_b64_tr_b16 v[32:33], v15 offset:0
  v_mfma_f32_32x32x16_bf16 v[144:159], v[48:51], v[40:43], v[144:159]
  ds_read_b64_tr_b16 v[34:35], v15 offset:1024
  ds_read_b64_tr_b16 v[36:37], v16 offset:0
  ds_read_b64_tr_b16 v[38:39], v16 offset:1024
  v_mfma_f32_32x32x16_bf16 v[160:175], v[52:55], v[40:43], v[160:175]
  s_waitcnt lgkmcnt(4)
  v_mfma_f32_32x32x16_bf16 v[128:143], v[28:31], v[24:27], v[128:143]
  ds_read_b128 v[40:43], v11 offset:32768
  ds_read_b64_tr_b16 v[44:45], v14 offset:4096
  ds_read_b64_tr_b16 v[46:47], v14 offset:5120
  ds_read_b64_tr_b16 v[48:49], v15 offset:4096
  s_waitcnt lgkmcnt(6)
  v_mfma_f32_32x32x16_bf16 v[144:159], v[32:35], v[24:27], v[144:159]
  ds_read_b64_tr_b16 v[50:51], v15 offset:5120
  ds_read_b64_tr_b16 v[52:53], v16 offset:4096
  ds_read_b64_tr_b16 v[54:55], v16 offset:5120
  s_waitcnt lgkmcnt(7)
  v_mfma_f32_32x32x16_bf16 v[160:175], v[36:39], v[24:27], v[160:175]
  s_waitcnt lgkmcnt(4)
  v_mfma_f32_32x32x16_bf16 v[128:143], v[44:47], v[40:43], v[128:143]
  ds_read_b128 v[24:27], v12 offset:32768
  ds_read_b64_tr_b16 v[28:29], v14 offset:8192
  ds_read_b64_tr_b16 v[30:31], v14 offset:9216
  ds_read_b64_tr_b16 v[32:33], v15 offset:8192
  s_waitcnt lgkmcnt(6)
  v_mfma_f32_32x32x16_bf16 v[144:159], v[48:51], v[40:43], v[144:159]
  ds_read_b64_tr_b16 v[34:35], v15 offset:9216
  ds_read_b64_tr_b16 v[36:37], v16 offset:8192
  ds_read_b64_tr_b16 v[38:39], v16 offset:9216
  s_waitcnt lgkmcnt(7)
  v_mfma_f32_32x32x16_bf16 v[160:175], v[52:55], v[40:43], v[160:175]
  s_waitcnt lgkmcnt(4)
  v_mfma_f32_32x32x16_bf16 v[128:143], v[28:31], v[24:27], v[128:143]
  ds_read_b128 v[40:43], v13 offset:32768
  ds_read_b64_tr_b16 v[44:45], v14 offset:12288
  ds_read_b64_tr_b16 v[46:47], v14 offset:13312
  ds_read_b64_tr_b16 v[48:49], v15 offset:12288
  s_waitcnt lgkmcnt(6)
  v_mfma_f32_32x32x16_bf16 v[144:159], v[32:35], v[24:27], v[144:159]
  ds_read_b64_tr_b16 v[50:51], v15 offset:13312
  ds_read_b64_tr_b16 v[52:53], v16 offset:12288
  ds_read_b64_tr_b16 v[54:55], v16 offset:13312
  s_waitcnt lgkmcnt(7)
  v_mfma_f32_32x32x16_bf16 v[160:175], v[36:39], v[24:27], v[160:175]
  s_waitcnt lgkmcnt(4)
  v_mfma_f32_32x32x16_bf16 v[128:143], v[44:47], v[40:43], v[128:143]
  s_waitcnt lgkmcnt(0)
  s_barrier
  v_add_u32 v10, s67, v10
  v_add_u32 v11, s67, v11
  v_add_u32 v12, s67, v12
  v_add_u32 v13, s67, v13
  v_subrev_u32 v10, 65536, v10
  v_subrev_u32 v11, 65536, v11
  v_subrev_u32 v12, 65536, v12
  v_subrev_u32 v13, 65536, v13
  ds_read_b64_tr_b16 v[32:33], v19 offset:16384
  ds_read_b64_tr_b16 v[34:35], v19 offset:17408
  ds_read_b128 v[24:27], v10 offset:0
  v_mfma_f32_32x32x16_bf16 v[144:159], v[48:51], v[40:43], v[144:159]
  ds_read_b128 v[28:31], v10 offset:4096
  ds_read_b64_tr_b16 v[36:37], v20 offset:16384
  ds_read_b64_tr_b16 v[38:39], v20 offset:17408
  v_mfma_f32_32x32x16_bf16 v[160:175], v[52:55], v[40:43], v[160:175]
  s_waitcnt lgkmcnt(3)
  v_mfma_f32_32x32x16_bf16 v[64:79], v[32:35], v[24:27], v[64:79]
  ds_read_b64_tr_b16 v[48:49], v19 offset:20480
  ds_read_b64_tr_b16 v[50:51], v19 offset:21504
  ds_read_b128 v[40:43], v11 offset:0
  v_max_f32 v56, 0, v128
  v_max_f32 v57, 0, v129
  v_max_f32 v58, 0, v130
  v_max_f32 v59, 0, v131
  s_waitcnt lgkmcnt(5)
  v_mfma_f32_32x32x16_bf16 v[80:95], v[32:35], v[28:31], v[80:95]
  ds_read_b128 v[44:47], v11 offset:4096
  ds_read_b64_tr_b16 v[52:53], v20 offset:20480
  ds_read_b64_tr_b16 v[54:55], v20 offset:21504
  v_mul_f32 v128, v128, v56
  v_mul_f32 v129, v129, v57
  v_mul_f32 v130, v130, v58
  v_mul_f32 v131, v131, v59
  s_waitcnt lgkmcnt(6)
  v_mfma_f32_32x32x16_bf16 v[96:111], v[36:39], v[24:27], v[96:111]
  v_max_f32 v56, 0, v132
  v_max_f32 v57, 0, v133
  v_max_f32 v58, 0, v134
  v_max_f32 v59, 0, v135
  v_mfma_f32_32x32x16_bf16 v[112:127], v[36:39], v[28:31], v[112:127]
  v_mul_f32 v132, v132, v56
  v_mul_f32 v133, v133, v57
  v_mul_f32 v134, v134, v58
  v_mul_f32 v135, v135, v59
  s_waitcnt lgkmcnt(3)
  v_mfma_f32_32x32x16_bf16 v[64:79], v[48:51], v[40:43], v[64:79]
  ds_read_b64_tr_b16 v[32:33], v19 offset:24576
  ds_read_b64_tr_b16 v[34:35], v19 offset:25600
  ds_read_b128 v[24:27], v12 offset:0
  v_cvt_pk_bf16_f32 v176, v128, v129
  v_cvt_pk_bf16_f32 v177, v130, v131
  v_cvt_pk_bf16_f32 v178, v132, v133
  v_cvt_pk_bf16_f32 v179, v134, v135
  s_waitcnt lgkmcnt(5)
  v_mfma_f32_32x32x16_bf16 v[80:95], v[48:51], v[44:47], v[80:95]
  ds_read_b128 v[28:31], v12 offset:4096
  ds_read_b64_tr_b16 v[36:37], v20 offset:24576
  ds_read_b64_tr_b16 v[38:39], v20 offset:25600
  buffer_store_dwordx4 v[176:179], v17, s[44:47], s64 offen offset:0 sc1
  v_max_f32 v56, 0, v136
  v_max_f32 v57, 0, v137
  v_max_f32 v58, 0, v138
  s_waitcnt lgkmcnt(6)
  v_mfma_f32_32x32x16_bf16 v[96:111], v[52:55], v[40:43], v[96:111]
  v_max_f32 v59, 0, v139
  v_mul_f32 v136, v136, v56
  v_mul_f32 v137, v137, v57
  v_mul_f32 v138, v138, v58
  v_mfma_f32_32x32x16_bf16 v[112:127], v[52:55], v[44:47], v[112:127]
  v_mul_f32 v139, v139, v59
  v_max_f32 v56, 0, v140
  v_max_f32 v57, 0, v141
  v_max_f32 v58, 0, v142
  s_waitcnt lgkmcnt(3)
  v_mfma_f32_32x32x16_bf16 v[64:79], v[32:35], v[24:27], v[64:79]
  ds_read_b64_tr_b16 v[48:49], v19 offset:28672
  ds_read_b64_tr_b16 v[50:51], v19 offset:29696
  ds_read_b128 v[40:43], v13 offset:0
  v_max_f32 v59, 0, v143
  v_mul_f32 v140, v140, v56
  v_mul_f32 v141, v141, v57
  v_mul_f32 v142, v142, v58
  s_waitcnt lgkmcnt(5)
  v_mfma_f32_32x32x16_bf16 v[80:95], v[32:35], v[28:31], v[80:95]
  ds_read_b128 v[44:47], v13 offset:4096
  ds_read_b64_tr_b16 v[52:53], v20 offset:28672
  ds_read_b64_tr_b16 v[54:55], v20 offset:29696
  v_mul_f32 v143, v143, v59
  v_cvt_pk_bf16_f32 v180, v136, v137
  v_cvt_pk_bf16_f32 v181, v138, v139
  v_cvt_pk_bf16_f32 v182, v140, v141
  s_waitcnt lgkmcnt(6)
  v_mfma_f32_32x32x16_bf16 v[96:111], v[36:39], v[24:27], v[96:111]
  v_cvt_pk_bf16_f32 v183, v142, v143
  buffer_store_dwordx4 v[180:183], v17, s[44:47], s64 offen offset:2048 sc1
  s_add_u32 s64, s64, 4096
  v_max_f32 v56, 0, v144
  v_mfma_f32_32x32x16_bf16 v[112:127], v[36:39], v[28:31], v[112:127]
  v_max_f32 v57, 0, v145
  v_max_f32 v58, 0, v146
  v_max_f32 v59, 0, v147
  v_mul_f32 v144, v144, v56
  s_waitcnt lgkmcnt(3)
  v_mfma_f32_32x32x16_bf16 v[64:79], v[48:51], v[40:43], v[64:79]
  s_waitcnt lgkmcnt(0)
  s_barrier
  ds_read_b64_tr_b16 v[32:33], v19 offset:32768
  ds_read_b64_tr_b16 v[34:35], v19 offset:33792
  ds_read_b128 v[24:27], v10 offset:16384
  v_mfma_f32_32x32x16_bf16 v[80:95], v[48:51], v[44:47], v[80:95]
  ds_read_b128 v[28:31], v10 offset:20480
  ds_read_b64_tr_b16 v[36:37], v20 offset:32768
  ds_read_b64_tr_b16 v[38:39], v20 offset:33792
  v_mul_f32 v145, v145, v57
  v_mul_f32 v146, v146, v58
  v_mul_f32 v147, v147, v59
  v_max_f32 v56, 0, v148
  v_mfma_f32_32x32x16_bf16 v[96:111], v[52:55], v[40:43], v[96:111]
  v_max_f32 v57, 0, v149
  v_max_f32 v58, 0, v150
  v_max_f32 v59, 0, v151
  v_mul_f32 v148, v148, v56
  v_mfma_f32_32x32x16_bf16 v[112:127], v[52:55], v[44:47], v[112:127]
  v_mul_f32 v149, v149, v57
  v_mul_f32 v150, v150, v58
  v_mul_f32 v151, v151, v59
  v_cvt_pk_bf16_f32 v176, v144, v145
  s_waitcnt lgkmcnt(3)
  v_mfma_f32_32x32x16_bf16 v[64:79], v[32:35], v[24:27], v[64:79]
  ds_read_b64_tr_b16 v[48:49], v19 offset:36864
  ds_read_b64_tr_b16 v[50:51], v19 offset:37888
  ds_read_b128 v[40:43], v11 offset:16384
  v_cvt_pk_bf16_f32 v177, v146, v147
  v_cvt_pk_bf16_f32 v178, v148, v149
  v_cvt_pk_bf16_f32 v179, v150, v151
  buffer_store_dwordx4 v[176:179], v17, s[44:47], s64 offen offset:0 sc1
  s_waitcnt lgkmcnt(5)
  v_mfma_f32_32x32x16_bf16 v[80:95], v[32:35], v[28:31], v[80:95]
  ds_read_b128 v[44:47], v11 offset:20480
  ds_read_b64_tr_b16 v[52:53], v20 offset:36864
  ds_read_b64_tr_b16 v[54:55], v20 offset:37888
  v_max_f32 v56, 0, v152
  v_max_f32 v57, 0, v153
  v_max_f32 v58, 0, v154
  v_max_f32 v59, 0, v155
  s_waitcnt lgkmcnt(6)
  v_mfma_f32_32x32x16_bf16 v[96:111], v[36:39], v[24:27], v[96:111]
  v_mul_f32 v152, v152, v56
  v_mul_f32 v153, v153, v57
  v_mul_f32 v154, v154, v58
  v_mul_f32 v155, v155, v59
  v_mfma_f32_32x32x16_bf16 v[112:127], v[36:39], v[28:31], v[112:127]
  v_max_f32 v56, 0, v156
  v_max_f32 v57, 0, v157
  v_max_f32 v58, 0, v158
  v_max_f32 v59, 0, v159
  s_waitcnt lgkmcnt(3)
  v_mfma_f32_32x32x16_bf16 v[64:79], v[48:51], v[40:43], v[64:79]
  ds_read_b64_tr_b16 v[32:33], v19 offset:40960
  ds_read_b64_tr_b16 v[34:35], v19 offset:41984
  ds_read_b128 v[24:27], v12 offset:16384
  v_mul_f32 v156, v156, v56
  v_mul_f32 v157, v157, v57
  v_mul_f32 v158, v158, v58
  v_mul_f32 v159, v159, v59
  s_waitcnt lgkmcnt(5)
  v_mfma_f32_32x32x16_bf16 v[80:95], v[48:51], v[44:47], v[80:95]
  ds_read_b128 v[28:31], v12 offset:20480
  ds_read_b64_tr_b16 v[36:37], v20 offset:40960
  ds_read_b64_tr_b16 v[38:39], v20 offset:41984
  v_cvt_pk_bf16_f32 v180, v152, v153
  v_cvt_pk_bf16_f32 v181, v154, v155
  v_cvt_pk_bf16_f32 v182, v156, v157
  v_cvt_pk_bf16_f32 v183, v158, v159
  s_waitcnt lgkmcnt(6)
  v_mfma_f32_32x32x16_bf16 v[96:111], v[52:55], v[40:43], v[96:111]
  buffer_store_dwordx4 v[180:183], v17, s[44:47], s64 offen offset:2048 sc1
  s_add_u32 s64, s64, 4096
  v_max_f32 v56, 0, v160
  v_max_f32 v57, 0, v161
  v_mfma_f32_32x32x16_bf16 v[112:127], v[52:55], v[44:47], v[112:127]
  v_max_f32 v58, 0, v162
  v_max_f32 v59, 0, v163
  v_mul_f32 v160, v160, v56
  v_mul_f32 v161, v161, v57
  s_waitcnt lgkmcnt(3)
  v_mfma_f32_32x32x16_bf16 v[64:79], v[32:35], v[24:27], v[64:79]
  ds_read_b64_tr_b16 v[48:49], v19 offset:45056
  ds_read_b64_tr_b16 v[50:51], v19 offset:46080
  ds_read_b128 v[40:43], v13 offset:16384
  v_mul_f32 v162, v162, v58
  v_mul_f32 v163, v163, v59
  v_max_f32 v56, 0, v164
  v_max_f32 v57, 0, v165
  s_waitcnt lgkmcnt(5)
  v_mfma_f32_32x32x16_bf16 v[80:95], v[32:35], v[28:31], v[80:95]
  ds_read_b128 v[44:47], v13 offset:20480
  ds_read_b64_tr_b16 v[52:53], v20 offset:45056
  ds_read_b64_tr_b16 v[54:55], v20 offset:46080
  v_max_f32 v58, 0, v166
  v_max_f32 v59, 0, v167
  v_mul_f32 v164, v164, v56
  v_mul_f32 v165, v165, v57
  s_waitcnt lgkmcnt(6)
  v_mfma_f32_32x32x16_bf16 v[96:111], v[36:39], v[24:27], v[96:111]
  v_mul_f32 v166, v166, v58
  v_mul_f32 v167, v167, v59
  v_cvt_pk_bf16_f32 v176, v160, v161
  v_cvt_pk_bf16_f32 v177, v162, v163
  v_mfma_f32_32x32x16_bf16 v[112:127], v[36:39], v[28:31], v[112:127]
  v_cvt_pk_bf16_f32 v178, v164, v165
  v_cvt_pk_bf16_f32 v179, v166, v167
  buffer_store_dwordx4 v[176:179], v17, s[44:47], s64 offen offset:0 sc1
  v_max_f32 v56, 0, v168
  s_waitcnt lgkmcnt(3)
  v_mfma_f32_32x32x16_bf16 v[64:79], v[48:51], v[40:43], v[64:79]
  s_waitcnt lgkmcnt(0)
  s_barrier
  ds_read_b64_tr_b16 v[32:33], v19 offset:0
  ds_read_b64_tr_b16 v[34:35], v19 offset:1024
  ds_read_b128 v[24:27], v10 offset:32768
  v_mfma_f32_32x32x16_bf16 v[80:95], v[48:51], v[44:47], v[80:95]
  ds_read_b128 v[28:31], v10 offset:36864
  ds_read_b64_tr_b16 v[36:37], v20 offset:0
  ds_read_b64_tr_b16 v[38:39], v20 offset:1024
  v_max_f32 v57, 0, v169
  v_max_f32 v58, 0, v170
  v_max_f32 v59, 0, v171
  v_mul_f32 v168, v168, v56
  v_mfma_f32_32x32x16_bf16 v[96:111], v[52:55], v[40:43], v[96:111]
  v_mul_f32 v169, v169, v57
  v_mul_f32 v170, v170, v58
  v_mul_f32 v171, v171, v59
  v_max_f32 v56, 0, v172
  v_mfma_f32_32x32x16_bf16 v[112:127], v[52:55], v[44:47], v[112:127]
  v_max_f32 v57, 0, v173
  v_max_f32 v58, 0, v174
  v_max_f32 v59, 0, v175
  v_mul_f32 v172, v172, v56
  s_waitcnt lgkmcnt(3)
  v_mfma_f32_32x32x16_bf16 v[64:79], v[32:35], v[24:27], v[64:79]
  ds_read_b64_tr_b16 v[48:49], v19 offset:4096
  ds_read_b64_tr_b16 v[50:51], v19 offset:5120
  ds_read_b128 v[40:43], v11 offset:32768
  v_mul_f32 v173, v173, v57
  v_mul_f32 v174, v174, v58
  v_mul_f32 v175, v175, v59
  v_cvt_pk_bf16_f32 v180, v168, v169
  s_waitcnt lgkmcnt(5)
  v_mfma_f32_32x32x16_bf16 v[80:95], v[32:35], v[28:31], v[80:95]
  ds_read_b128 v[44:47], v11 offset:36864
  ds_read_b64_tr_b16 v[52:53], v20 offset:4096
  ds_read_b64_tr_b16 v[54:55], v20 offset:5120
  v_cvt_pk_bf16_f32 v181, v170, v171
  v_cvt_pk_bf16_f32 v182, v172, v173
  v_cvt_pk_bf16_f32 v183, v174, v175
  buffer_store_dwordx4 v[180:183], v17, s[44:47], s64 offen offset:2048 sc1
  s_waitcnt lgkmcnt(6)
  v_mfma_f32_32x32x16_bf16 v[96:111], v[36:39], v[24:27], v[96:111]
  v_mfma_f32_32x32x16_bf16 v[112:127], v[36:39], v[28:31], v[112:127]
  s_waitcnt lgkmcnt(3)
  v_mfma_f32_32x32x16_bf16 v[64:79], v[48:51], v[40:43], v[64:79]
  ds_read_b64_tr_b16 v[32:33], v19 offset:8192
  ds_read_b64_tr_b16 v[34:35], v19 offset:9216
  ds_read_b128 v[24:27], v12 offset:32768
  s_waitcnt lgkmcnt(5)
  v_mfma_f32_32x32x16_bf16 v[80:95], v[48:51], v[44:47], v[80:95]
  ds_read_b128 v[28:31], v12 offset:36864
  ds_read_b64_tr_b16 v[36:37], v20 offset:8192
  ds_read_b64_tr_b16 v[38:39], v20 offset:9216
  s_waitcnt lgkmcnt(6)
  v_mfma_f32_32x32x16_bf16 v[96:111], v[52:55], v[40:43], v[96:111]
  v_mfma_f32_32x32x16_bf16 v[112:127], v[52:55], v[44:47], v[112:127]
  s_waitcnt lgkmcnt(3)
  v_mfma_f32_32x32x16_bf16 v[64:79], v[32:35], v[24:27], v[64:79]
  ds_read_b64_tr_b16 v[48:49], v19 offset:12288
  ds_read_b64_tr_b16 v[50:51], v19 offset:13312
  ds_read_b128 v[40:43], v13 offset:32768
  s_waitcnt lgkmcnt(5)
  v_mfma_f32_32x32x16_bf16 v[80:95], v[32:35], v[28:31], v[80:95]
  ds_read_b128 v[44:47], v13 offset:36864
  ds_read_b64_tr_b16 v[52:53], v20 offset:12288
  ds_read_b64_tr_b16 v[54:55], v20 offset:13312
  s_waitcnt lgkmcnt(6)
  v_mfma_f32_32x32x16_bf16 v[96:111], v[36:39], v[24:27], v[96:111]
  v_mfma_f32_32x32x16_bf16 v[112:127], v[36:39], v[28:31], v[112:127]
  s_waitcnt lgkmcnt(3)
  v_mfma_f32_32x32x16_bf16 v[64:79], v[48:51], v[40:43], v[64:79]
  s_waitcnt lgkmcnt(0)
  s_barrier
  ds_read_b64_tr_b16 v[32:33], v19 offset:16384
  ds_read_b64_tr_b16 v[34:35], v19 offset:17408
  ds_read_b128 v[24:27], v10 offset:49152
  v_mfma_f32_32x32x16_bf16 v[80:95], v[48:51], v[44:47], v[80:95]
  ds_read_b128 v[28:31], v10 offset:53248
  ds_read_b64_tr_b16 v[36:37], v20 offset:16384
  ds_read_b64_tr_b16 v[38:39], v20 offset:17408
  v_mfma_f32_32x32x16_bf16 v[96:111], v[52:55], v[40:43], v[96:111]
  v_mfma_f32_32x32x16_bf16 v[112:127], v[52:55], v[44:47], v[112:127]
  s_waitcnt lgkmcnt(3)
  v_mfma_f32_32x32x16_bf16 v[64:79], v[32:35], v[24:27], v[64:79]
  ds_read_b64_tr_b16 v[48:49], v19 offset:20480
  ds_read_b64_tr_b16 v[50:51], v19 offset:21504
  ds_read_b128 v[40:43], v11 offset:49152
  s_waitcnt lgkmcnt(5)
  v_mfma_f32_32x32x16_bf16 v[80:95], v[32:35], v[28:31], v[80:95]
  ds_read_b128 v[44:47], v11 offset:53248
  ds_read_b64_tr_b16 v[52:53], v20 offset:20480
  ds_read_b64_tr_b16 v[54:55], v20 offset:21504
  s_waitcnt lgkmcnt(6)
  v_mfma_f32_32x32x16_bf16 v[96:111], v[36:39], v[24:27], v[96:111]
  v_mfma_f32_32x32x16_bf16 v[112:127], v[36:39], v[28:31], v[112:127]
  s_waitcnt lgkmcnt(3)
  v_mfma_f32_32x32x16_bf16 v[64:79], v[48:51], v[40:43], v[64:79]
  ds_read_b64_tr_b16 v[32:33], v19 offset:24576
  ds_read_b64_tr_b16 v[34:35], v19 offset:25600
  ds_read_b128 v[24:27], v12 offset:49152
  s_waitcnt lgkmcnt(5)
  v_mfma_f32_32x32x16_bf16 v[80:95], v[48:51], v[44:47], v[80:95]
  ds_read_b128 v[28:31], v12 offset:53248
  ds_read_b64_tr_b16 v[36:37], v20 offset:24576
  ds_read_b64_tr_b16 v[38:39], v20 offset:25600
  s_waitcnt lgkmcnt(6)
  v_mfma_f32_32x32x16_bf16 v[96:111], v[52:55], v[40:43], v[96:111]
  v_mfma_f32_32x32x16_bf16 v[112:127], v[52:55], v[44:47], v[112:127]
  s_waitcnt lgkmcnt(3)
  v_mfma_f32_32x32x16_bf16 v[64:79], v[32:35], v[24:27], v[64:79]
  ds_read_b64_tr_b16 v[48:49], v19 offset:28672
  ds_read_b64_tr_b16 v[50:51], v19 offset:29696
  ds_read_b128 v[40:43], v13 offset:49152
  s_waitcnt lgkmcnt(5)
  v_mfma_f32_32x32x16_bf16 v[80:95], v[32:35], v[28:31], v[80:95]
  ds_read_b128 v[44:47], v13 offset:53248
  ds_read_b64_tr_b16 v[52:53], v20 offset:28672
  ds_read_b64_tr_b16 v[54:55], v20 offset:29696
  s_waitcnt lgkmcnt(6)
  v_mfma_f32_32x32x16_bf16 v[96:111], v[36:39], v[24:27], v[96:111]
  v_mfma_f32_32x32x16_bf16 v[112:127], v[36:39], v[28:31], v[112:127]
  s_waitcnt lgkmcnt(3)
  v_mfma_f32_32x32x16_bf16 v[64:79], v[48:51], v[40:43], v[64:79]
  s_waitcnt lgkmcnt(0)
  s_waitcnt vmcnt(0)
  s_barrier
  s_cmp_lg_u32 s28, 0
  s_cbranch_scc1 Lpub_19
  v_mov_b32 v7, s74
  v_mov_b32 v8, 0
  s_mov_b64 exec, 1
  buffer_store_dword v7, v8, s[44:47], s81 offen sc1
  s_mov_b64 exec, -1
Lpub_19:
  v_add_u32 v10, 65536, v10
  v_add_u32 v11, 65536, v11
  v_add_u32 v12, 65536, v12
  v_add_u32 v13, 65536, v13
  ds_read_b64_tr_b16 v[32:33], v19 offset:32768
  ds_read_b64_tr_b16 v[34:35], v19 offset:33792
  ds_read_b128 v[24:27], v10 offset:0
  v_mfma_f32_32x32x16_bf16 v[80:95], v[48:51], v[44:47], v[80:95]
  ds_read_b128 v[28:31], v10 offset:4096
  ds_read_b64_tr_b16 v[36:37], v20 offset:32768
  ds_read_b64_tr_b16 v[38:39], v20 offset:33792
  v_mfma_f32_32x32x16_bf16 v[96:111], v[52:55], v[40:43], v[96:111]
  v_mfma_f32_32x32x16_bf16 v[112:127], v[52:55], v[44:47], v[112:127]
  s_waitcnt lgkmcnt(3)
  v_mfma_f32_32x32x16_bf16 v[64:79], v[32:35], v[24:27], v[64:79]
  ds_read_b64_tr_b16 v[48:49], v19 offset:36864
  ds_read_b64_tr_b16 v[50:51], v19 offset:37888
  ds_read_b128 v[40:43], v11 offset:0
  s_waitcnt lgkmcnt(5)
  v_mfma_f32_32x32x16_bf16 v[80:95], v[32:35], v[28:31], v[80:95]
  ds_read_b128 v[44:47], v11 offset:4096
  ds_read_b64_tr_b16 v[52:53], v20 offset:36864
  ds_read_b64_tr_b16 v[54:55], v20 offset:37888
  s_waitcnt lgkmcnt(6)
  v_mfma_f32_32x32x16_bf16 v[96:111], v[36:39], v[24:27], v[96:111]
  v_mfma_f32_32x32x16_bf16 v[112:127], v[36:39], v[28:31], v[112:127]
  s_waitcnt lgkmcnt(3)
  v_mfma_f32_32x32x16_bf16 v[64:79], v[48:51], v[40:43], v[64:79]
  ds_read_b64_tr_b16 v[32:33], v19 offset:40960
  ds_read_b64_tr_b16 v[34:35], v19 offset:41984
  ds_read_b128 v[24:27], v12 offset:0
  s_waitcnt lgkmcnt(5)
  v_mfma_f32_32x32x16_bf16 v[80:95], v[48:51], v[44:47], v[80:95]
  ds_read_b128 v[28:31], v12 offset:4096
  ds_read_b64_tr_b16 v[36:37], v20 offset:40960
  ds_read_b64_tr_b16 v[38:39], v20 offset:41984
  s_waitcnt lgkmcnt(6)
  v_mfma_f32_32x32x16_bf16 v[96:111], v[52:55], v[40:43], v[96:111]
  v_mfma_f32_32x32x16_bf16 v[112:127], v[52:55], v[44:47], v[112:127]
  s_waitcnt lgkmcnt(3)
  v_mfma_f32_32x32x16_bf16 v[64:79], v[32:35], v[24:27], v[64:79]
  ds_read_b64_tr_b16 v[48:49], v19 offset:45056
  ds_read_b64_tr_b16 v[50:51], v19 offset:46080
  ds_read_b128 v[40:43], v13 offset:0
  s_waitcnt lgkmcnt(5)
  v_mfma_f32_32x32x16_bf16 v[80:95], v[32:35], v[28:31], v[80:95]
  ds_read_b128 v[44:47], v13 offset:4096
  ds_read_b64_tr_b16 v[52:53], v20 offset:45056
  ds_read_b64_tr_b16 v[54:55], v20 offset:46080
  s_waitcnt lgkmcnt(6)
  v_mfma_f32_32x32x16_bf16 v[96:111], v[36:39], v[24:27], v[96:111]
  v_mfma_f32_32x32x16_bf16 v[112:127], v[36:39], v[28:31], v[112:127]
  s_waitcnt lgkmcnt(3)
  v_mfma_f32_32x32x16_bf16 v[64:79], v[48:51], v[40:43], v[64:79]
  s_waitcnt lgkmcnt(0)
  s_barrier
  ds_read_b64_tr_b16 v[32:33], v19 offset:0
  ds_read_b64_tr_b16 v[34:35], v19 offset:1024
  ds_read_b128 v[24:27], v10 offset:16384
  v_mfma_f32_32x32x16_bf16 v[80:95], v[48:51], v[44:47], v[80:95]
  ds_read_b128 v[28:31], v10 offset:20480
  ds_read_b64_tr_b16 v[36:37], v20 offset:0
  ds_read_b64_tr_b16 v[38:39], v20 offset:1024
  v_mfma_f32_32x32x16_bf16 v[96:111], v[52:55], v[40:43], v[96:111]
  v_mfma_f32_32x32x16_bf16 v[112:127], v[52:55], v[44:47], v[112:127]
  s_waitcnt lgkmcnt(3)
  v_mfma_f32_32x32x16_bf16 v[64:79], v[32:35], v[24:27], v[64:79]
  ds_read_b64_tr_b16 v[48:49], v19 offset:4096
  ds_read_b64_tr_b16 v[50:51], v19 offset:5120
  ds_read_b128 v[40:43], v11 offset:16384
  s_waitcnt lgkmcnt(5)
  v_mfma_f32_32x32x16_bf16 v[80:95], v[32:35], v[28:31], v[80:95]
  ds_read_b128 v[44:47], v11 offset:20480
  ds_read_b64_tr_b16 v[52:53], v20 offset:4096
  ds_read_b64_tr_b16 v[54:55], v20 offset:5120
  s_waitcnt lgkmcnt(6)
  v_mfma_f32_32x32x16_bf16 v[96:111], v[36:39], v[24:27], v[96:111]
  v_mfma_f32_32x32x16_bf16 v[112:127], v[36:39], v[28:31], v[112:127]
  s_waitcnt lgkmcnt(3)
  v_mfma_f32_32x32x16_bf16 v[64:79], v[48:51], v[40:43], v[64:79]
  ds_read_b64_tr_b16 v[32:33], v19 offset:8192
  ds_read_b64_tr_b16 v[34:35], v19 offset:9216
  ds_read_b128 v[24:27], v12 offset:16384
  s_waitcnt lgkmcnt(5)
  v_mfma_f32_32x32x16_bf16 v[80:95], v[48:51], v[44:47], v[80:95]
  ds_read_b128 v[28:31], v12 offset:20480
  ds_read_b64_tr_b16 v[36:37], v20 offset:8192
  ds_read_b64_tr_b16 v[38:39], v20 offset:9216
  s_waitcnt lgkmcnt(6)
  v_mfma_f32_32x32x16_bf16 v[96:111], v[52:55], v[40:43], v[96:111]
  v_mfma_f32_32x32x16_bf16 v[112:127], v[52:55], v[44:47], v[112:127]
  s_waitcnt lgkmcnt(3)
  v_mfma_f32_32x32x16_bf16 v[64:79], v[32:35], v[24:27], v[64:79]
  ds_read_b64_tr_b16 v[48:49], v19 offset:12288
  ds_read_b64_tr_b16 v[50:51], v19 offset:13312
  ds_read_b128 v[40:43], v13 offset:16384
  s_waitcnt lgkmcnt(5)
  v_mfma_f32_32x32x16_bf16 v[80:95], v[32:35], v[28:31], v[80:95]
  ds_read_b128 v[44:47], v13 offset:20480
  ds_read_b64_tr_b16 v[52:53], v20 offset:12288
  ds_read_b64_tr_b16 v[54:55], v20 offset:13312
  s_waitcnt lgkmcnt(6)
  v_mfma_f32_32x32x16_bf16 v[96:111], v[36:39], v[24:27], v[96:111]
  v_mfma_f32_32x32x16_bf16 v[112:127], v[36:39], v[28:31], v[112:127]
  s_waitcnt lgkmcnt(3)
  v_mfma_f32_32x32x16_bf16 v[64:79], v[48:51], v[40:43], v[64:79]
  s_waitcnt lgkmcnt(0)
  s_barrier
  ds_read_b64_tr_b16 v[32:33], v19 offset:16384
  ds_read_b64_tr_b16 v[34:35], v19 offset:17408
  ds_read_b128 v[24:27], v10 offset:32768
  v_mfma_f32_32x32x16_bf16 v[80:95], v[48:51], v[44:47], v[80:95]
  ds_read_b128 v[28:31], v10 offset:36864
  ds_read_b64_tr_b16 v[36:37], v20 offset:16384
  ds_read_b64_tr_b16 v[38:39], v20 offset:17408
  v_mfma_f32_32x32x16_bf16 v[96:111], v[52:55], v[40:43], v[96:111]
  v_mfma_f32_32x32x16_bf16 v[112:127], v[52:55], v[44:47], v[112:127]
  s_waitcnt lgkmcnt(3)
  v_mfma_f32_32x32x16_bf16 v[64:79], v[32:35], v[24:27], v[64:79]
  ds_read_b64_tr_b16 v[48:49], v19 offset:20480
  ds_read_b64_tr_b16 v[50:51], v19 offset:21504
  ds_read_b128 v[40:43], v11 offset:32768
  s_waitcnt lgkmcnt(5)
  v_mfma_f32_32x32x16_bf16 v[80:95], v[32:35], v[28:31], v[80:95]
  ds_read_b128 v[44:47], v11 offset:36864
  ds_read_b64_tr_b16 v[52:53], v20 offset:20480
  ds_read_b64_tr_b16 v[54:55], v20 offset:21504
  s_waitcnt lgkmcnt(6)
  v_mfma_f32_32x32x16_bf16 v[96:111], v[36:39], v[24:27], v[96:111]
  v_mfma_f32_32x32x16_bf16 v[112:127], v[36:39], v[28:31], v[112:127]
  s_waitcnt lgkmcnt(3)
  v_mfma_f32_32x32x16_bf16 v[64:79], v[48:51], v[40:43], v[64:79]
  ds_read_b64_tr_b16 v[32:33], v19 offset:24576
  ds_read_b64_tr_b16 v[34:35], v19 offset:25600
  ds_read_b128 v[24:27], v12 offset:32768
  s_waitcnt lgkmcnt(5)
  v_mfma_f32_32x32x16_bf16 v[80:95], v[48:51], v[44:47], v[80:95]
  ds_read_b128 v[28:31], v12 offset:36864
  ds_read_b64_tr_b16 v[36:37], v20 offset:24576
  ds_read_b64_tr_b16 v[38:39], v20 offset:25600
  s_waitcnt lgkmcnt(6)
  v_mfma_f32_32x32x16_bf16 v[96:111], v[52:55], v[40:43], v[96:111]
  v_mfma_f32_32x32x16_bf16 v[112:127], v[52:55], v[44:47], v[112:127]
  s_waitcnt lgkmcnt(3)
  v_mfma_f32_32x32x16_bf16 v[64:79], v[32:35], v[24:27], v[64:79]
  ds_read_b64_tr_b16 v[48:49], v19 offset:28672
  ds_read_b64_tr_b16 v[50:51], v19 offset:29696
  ds_read_b128 v[40:43], v13 offset:32768
  s_waitcnt lgkmcnt(5)
  v_mfma_f32_32x32x16_bf16 v[80:95], v[32:35], v[28:31], v[80:95]
  ds_read_b128 v[44:47], v13 offset:36864
  ds_read_b64_tr_b16 v[52:53], v20 offset:28672
  ds_read_b64_tr_b16 v[54:55], v20 offset:29696
  s_waitcnt lgkmcnt(6)
  v_mfma_f32_32x32x16_bf16 v[96:111], v[36:39], v[24:27], v[96:111]
  v_mfma_f32_32x32x16_bf16 v[112:127], v[36:39], v[28:31], v[112:127]
  s_waitcnt lgkmcnt(3)
  v_mfma_f32_32x32x16_bf16 v[64:79], v[48:51], v[40:43], v[64:79]
  s_waitcnt lgkmcnt(0)
  s_barrier
  v_mfma_f32_32x32x16_bf16 v[80:95], v[48:51], v[44:47], v[80:95]
  v_mfma_f32_32x32x16_bf16 v[96:111], v[52:55], v[40:43], v[96:111]
  v_mfma_f32_32x32x16_bf16 v[112:127], v[52:55], v[44:47], v[112:127]
  s_nop 6
  v_max_f32 v56, 0, v64
  v_max_f32 v57, 0, v65
  v_max_f32 v58, 0, v66
  v_max_f32 v59, 0, v67
  v_mul_f32 v64, v64, v56
  v_mul_f32 v65, v65, v57
  v_mul_f32 v66, v66, v58
  v_mul_f32 v67, v67, v59
  v_max_f32 v56, 0, v68
  v_max_f32 v57, 0, v69
  v_max_f32 v58, 0, v70
  v_max_f32 v59, 0, v71
  v_mul_f32 v68, v68, v56
  v_mul_f32 v69, v69, v57
  v_mul_f32 v70, v70, v58
  v_mul_f32 v71, v71, v59
  v_cvt_pk_bf16_f32 v176, v64, v65
  v_cvt_pk_bf16_f32 v177, v66, v67
  v_cvt_pk_bf16_f32 v178, v68, v69
  v_cvt_pk_bf16_f32 v179, v70, v71
  buffer_store_dwordx4 v[176:179], v17, s[44:47], s65 offen offset:0 sc1
  v_max_f32 v56, 0, v72
  v_max_f32 v57, 0, v73
  v_max_f32 v58, 0, v74
  v_max_f32 v59, 0, v75
  v_mul_f32 v72, v72, v56
  v_mul_f32 v73, v73, v57
  v_mul_f32 v74, v74, v58
  v_mul_f32 v75, v75, v59
  v_max_f32 v56, 0, v76
  v_max_f32 v57, 0, v77
  v_max_f32 v58, 0, v78
  v_max_f32 v59, 0, v79
  v_mul_f32 v76, v76, v56
  v_mul_f32 v77, v77, v57
  v_mul_f32 v78, v78, v58
  v_mul_f32 v79, v79, v59
  v_cvt_pk_bf16_f32 v180, v72, v73
  v_cvt_pk_bf16_f32 v181, v74, v75
  v_cvt_pk_bf16_f32 v182, v76, v77
  v_cvt_pk_bf16_f32 v183, v78, v79
  buffer_store_dwordx4 v[180:183], v17, s[44:47], s65 offen offset:2048 sc1
  v_max_f32 v56, 0, v80
  v_max_f32 v57, 0, v81
  v_max_f32 v58, 0, v82
  v_max_f32 v59, 0, v83
  v_mul_f32 v80, v80, v56
  v_mul_f32 v81, v81, v57
  v_mul_f32 v82, v82, v58
  v_mul_f32 v83, v83, v59
  v_max_f32 v56, 0, v84
  v_max_f32 v57, 0, v85
  v_max_f32 v58, 0, v86
  v_max_f32 v59, 0, v87
  v_mul_f32 v84, v84, v56
  v_mul_f32 v85, v85, v57
  v_mul_f32 v86, v86, v58
  v_mul_f32 v87, v87, v59
  v_cvt_pk_bf16_f32 v176, v80, v81
  v_cvt_pk_bf16_f32 v177, v82, v83
  v_cvt_pk_bf16_f32 v178, v84, v85
  v_cvt_pk_bf16_f32 v179, v86, v87
  buffer_store_dwordx4 v[176:179], v17, s[44:47], s65 offen offset:512 sc1
  v_max_f32 v56, 0, v88
  v_max_f32 v57, 0, v89
  v_max_f32 v58, 0, v90
  v_max_f32 v59, 0, v91
  v_mul_f32 v88, v88, v56
  v_mul_f32 v89, v89, v57
  v_mul_f32 v90, v90, v58
  v_mul_f32 v91, v91, v59
  v_max_f32 v56, 0, v92
  v_max_f32 v57, 0, v93
  v_max_f32 v58, 0, v94
  v_max_f32 v59, 0, v95
  v_mul_f32 v92, v92, v56
  v_mul_f32 v93, v93, v57
  v_mul_f32 v94, v94, v58
  v_mul_f32 v95, v95, v59
  v_cvt_pk_bf16_f32 v180, v88, v89
  v_cvt_pk_bf16_f32 v181, v90, v91
  v_cvt_pk_bf16_f32 v182, v92, v93
  v_cvt_pk_bf16_f32 v183, v94, v95
  buffer_store_dwordx4 v[180:183], v17, s[44:47], s65 offen offset:2560 sc1
  v_max_f32 v56, 0, v96
  v_max_f32 v57, 0, v97
  v_max_f32 v58, 0, v98
  v_max_f32 v59, 0, v99
  v_mul_f32 v96, v96, v56
  v_mul_f32 v97, v97, v57
  v_mul_f32 v98, v98, v58
  v_mul_f32 v99, v99, v59
  v_max_f32 v56, 0, v100
  v_max_f32 v57, 0, v101
  v_max_f32 v58, 0, v102
  v_max_f32 v59, 0, v103
  v_mul_f32 v100, v100, v56
  v_mul_f32 v101, v101, v57
  v_mul_f32 v102, v102, v58
  v_mul_f32 v103, v103, v59
  v_cvt_pk_bf16_f32 v176, v96, v97
  v_cvt_pk_bf16_f32 v177, v98, v99
  v_cvt_pk_bf16_f32 v178, v100, v101
  v_cvt_pk_bf16_f32 v179, v102, v103
  buffer_store_dwordx4 v[176:179], v17, s[44:47], s66 offen offset:0 sc1
  v_max_f32 v56, 0, v104
  v_max_f32 v57, 0, v105
  v_max_f32 v58, 0, v106
  v_max_f32 v59, 0, v107
  v_mul_f32 v104, v104, v56
  v_mul_f32 v105, v105, v57
  v_mul_f32 v106, v106, v58
  v_mul_f32 v107, v107, v59
  v_max_f32 v56, 0, v108
  v_max_f32 v57, 0, v109
  v_max_f32 v58, 0, v110
  v_max_f32 v59, 0, v111
  v_mul_f32 v108, v108, v56
  v_mul_f32 v109, v109, v57
  v_mul_f32 v110, v110, v58
  v_mul_f32 v111, v111, v59
  v_cvt_pk_bf16_f32 v180, v104, v105
  v_cvt_pk_bf16_f32 v181, v106, v107
  v_cvt_pk_bf16_f32 v182, v108, v109
  v_cvt_pk_bf16_f32 v183, v110, v111
  buffer_store_dwordx4 v[180:183], v17, s[44:47], s66 offen offset:2048 sc1
  v_max_f32 v56, 0, v112
  v_max_f32 v57, 0, v113
  v_max_f32 v58, 0, v114
  v_max_f32 v59, 0, v115
  v_mul_f32 v112, v112, v56
  v_mul_f32 v113, v113, v57
  v_mul_f32 v114, v114, v58
  v_mul_f32 v115, v115, v59
  v_max_f32 v56, 0, v116
  v_max_f32 v57, 0, v117
  v_max_f32 v58, 0, v118
  v_max_f32 v59, 0, v119
  v_mul_f32 v116, v116, v56
  v_mul_f32 v117, v117, v57
  v_mul_f32 v118, v118, v58
  v_mul_f32 v119, v119, v59
  v_cvt_pk_bf16_f32 v176, v112, v113
  v_cvt_pk_bf16_f32 v177, v114, v115
  v_cvt_pk_bf16_f32 v178, v116, v117
  v_cvt_pk_bf16_f32 v179, v118, v119
  buffer_store_dwordx4 v[176:179], v17, s[44:47], s66 offen offset:512 sc1
  v_max_f32 v56, 0, v120
  v_max_f32 v57, 0, v121
  v_max_f32 v58, 0, v122
  v_max_f32 v59, 0, v123
  v_mul_f32 v120, v120, v56
  v_mul_f32 v121, v121, v57
  v_mul_f32 v122, v122, v58
  v_mul_f32 v123, v123, v59
  v_max_f32 v56, 0, v124
  v_max_f32 v57, 0, v125
  v_max_f32 v58, 0, v126
  v_max_f32 v59, 0, v127
  v_mul_f32 v124, v124, v56
  v_mul_f32 v125, v125, v57
  v_mul_f32 v126, v126, v58
  v_mul_f32 v127, v127, v59
  v_cvt_pk_bf16_f32 v180, v120, v121
  v_cvt_pk_bf16_f32 v181, v122, v123
  v_cvt_pk_bf16_f32 v182, v124, v125
  v_cvt_pk_bf16_f32 v183, v126, v127
  buffer_store_dwordx4 v[180:183], v17, s[44:47], s66 offen offset:2560 sc1
  s_cmp_eq_u32 s76, 0
  s_cbranch_scc1 L_stage2_cons
  s_waitcnt vmcnt(0)
  s_barrier
  s_cmp_lg_u32 s28, 0
  s_cbranch_scc1 Lpub_20
  v_mov_b32 v7, s74
  v_mov_b32 v8, 0
  s_mov_b64 exec, 1
  buffer_store_dword v7, v8, s[44:47], s82 offen sc1
  s_mov_b64 exec, -1
Lpub_20:
  s_endpgm
L_consA:
  s_and_b32 s60, s29, 1
  s_lshr_b32 s61, s29, 1
  s_mov_b32 s70, 1069066811
  s_mov_b32 s71, 897988541
  s_lshl_b32 s35, s60, 6
  v_bfe_u32 v7, v2, 1, 3
  v_add_u32 v8, s35, v2
  v_lshlrev_b32 v8, 7, v8
  v_or_b32 v9, 0, v3
  v_xor_b32 v9, v9, v7
  v_lshl_add_u32 v10, v9, 4, v8
  v_or_b32 v9, 2, v3
  v_xor_b32 v9, v9, v7
  v_lshl_add_u32 v11, v9, 4, v8
  v_or_b32 v9, 4, v3
  v_xor_b32 v9, v9, v7
  v_lshl_add_u32 v12, v9, 4, v8
  v_or_b32 v9, 6, v3
  v_xor_b32 v9, v9, v7
  v_lshl_add_u32 v13, v9, 4, v8
  s_lshl_b32 s62, s29, 5
  s_sub_u32 s62, s62, s35
  s_lshl_b32 s62, s62, 7
  v_lshlrev_b32 v8, 5, v4
  v_lshl_add_u32 v8, v6, 3, v8
  s_mul_i32 s35, s61, 56
  v_add_u32 v9, s35, v8
  v_lshrrev_b32 v7, 6, v9
  v_xor_b32 v7, v7, v5
  v_and_b32 v9, 63, v9
  v_lshl_add_u32 v9, v7, 6, v9
  v_lshl_add_u32 v7, v3, 3, v5
  v_lshl_add_u32 v9, v7, 8, v9
  v_add_u32 v14, 114688, v9
  v_xor_b32 v15, 128, v14
  v_lshlrev_b32 v9, 7, v7
  v_add_u32 v9, 114688, v9
  v_lshrrev_b32 v7, 1, v5
  v_add_u32 v16, 0, v8
  v_lshrrev_b32 v23, 6, v16
  v_xor_b32 v23, v23, v7
  v_and_b32 v16, 63, v16
  v_lshl_add_u32 v16, v23, 6, v16
  v_add_u32 v16, v16, v9
  v_add_u32 v17, 56, v8
  v_lshrrev_b32 v23, 6, v17
  v_xor_b32 v23, v23, v7
  v_and_b32 v17, 63, v17
  v_lshl_add_u32 v17, v23, 6, v17
  v_add_u32 v17, v17, v9
  v_lshlrev_b32 v20, 4, v3
  s_lshl_b32 s35, s29, 10
  s_add_u32 s35, s35, 114688
  v_add_u32 v20, s35, v20
  v_lshlrev_b32 v19, 4, v1
  v_lshlrev_b32 v18, 2, v1
  v_lshlrev_b32 v7, 4, v2
  v_lshl_add_u32 v21, v3, 10, v7
  v_min_u32 v22, 15, v1
  v_lshlrev_b32 v22, 2, v22
  s_lshl_b32 s63, s31, 13
  s_add_u32 s63, s63, 65536
  s_lshl_b32 s64, s30, 1
  s_add_u32 s64, s64, s61
  s_lshl_b32 s64, s64, 16
  s_lshl_b32 s35, s31, 13
  s_add_u32 s64, s64, s35
  s_lshl_b32 s35, s60, 9
  s_add_u32 s64, s64, s35
  s_add_u32 s64, s64, 3145728
  s_lshl_b32 s65, s31, 7
  s_lshl_b32 s35, s30, 2
  s_add_u32 s81, s65, s35
  s_add_u32 s81, s81, 4096
  s_add_u32 s66, s65, 4096
  s_add_u32 s65, s65, 5120
  s_lshl_b32 s82, s30, 7
  s_lshl_b32 s35, s31, 2
  s_add_u32 s82, s82, s35
  s_add_u32 s82, s82, 11264
  v_mov_b32 v64, 0
  v_mov_b32 v65, 0
  v_mov_b32 v66, 0
  v_mov_b32 v67, 0
  v_mov_b32 v68, 0
  v_mov_b32 v69, 0
  v_mov_b32 v70, 0
  v_mov_b32 v71, 0
  v_mov_b32 v72, 0
  v_mov_b32 v73, 0
  v_mov_b32 v74, 0
  v_mov_b32 v75, 0
  v_mov_b32 v76, 0
  v_mov_b32 v77, 0
  v_mov_b32 v78, 0
  v_mov_b32 v79, 0
  v_mov_b32 v80, 0
  v_mov_b32 v81, 0
  v_mov_b32 v82, 0
  v_mov_b32 v83, 0
  v_mov_b32 v84, 0
  v_mov_b32 v85, 0
  v_mov_b32 v86, 0
  v_mov_b32 v87, 0
  v_mov_b32 v88, 0
  v_mov_b32 v89, 0
  v_mov_b32 v90, 0
  v_mov_b32 v91, 0
  v_mov_b32 v92, 0
  v_mov_b32 v93, 0
  v_mov_b32 v94, 0
  v_mov_b32 v95, 0
  v_mov_b32 v96, 0
  v_mov_b32 v97, 0
  v_mov_b32 v98, 0
  v_mov_b32 v99, 0
  v_mov_b32 v100, 0
  v_mov_b32 v101, 0
  v_mov_b32 v102, 0
  v_mov_b32 v103, 0
  v_mov_b32 v104, 0
  v_mov_b32 v105, 0
  v_mov_b32 v106, 0
  v_mov_b32 v107, 0
  v_mov_b32 v108, 0
  v_mov_b32 v109, 0
  v_mov_b32 v110, 0
  v_mov_b32 v111, 0
  v_mov_b32 v112, 0
  v_mov_b32 v113, 0
  v_mov_b32 v114, 0
  v_mov_b32 v115, 0
  v_mov_b32 v116, 0
  v_mov_b32 v117, 0
  v_mov_b32 v118, 0
  v_mov_b32 v119, 0
  v_mov_b32 v120, 0
  v_mov_b32 v121, 0
  v_mov_b32 v122, 0
  v_mov_b32 v123, 0
  v_mov_b32 v124, 0
  v_mov_b32 v125, 0
  v_mov_b32 v126, 0
  v_mov_b32 v127, 0
  v_mov_b32 v128, 0
  v_mov_b32 v129, 0
  v_mov_b32 v130, 0
  v_mov_b32 v131, 0
  v_mov_b32 v132, 0
  v_mov_b32 v133, 0
  v_mov_b32 v134, 0
  v_mov_b32 v135, 0
  v_mov_b32 v136, 0
  v_mov_b32 v137, 0
  v_mov_b32 v138, 0
  v_mov_b32 v139, 0
  v_mov_b32 v140, 0
  v_mov_b32 v141, 0
  v_mov_b32 v142, 0
  v_mov_b32 v143, 0
  v_mov_b32 v144, 0
  v_mov_b32 v145, 0
  v_mov_b32 v146, 0
  v_mov_b32 v147, 0
  v_mov_b32 v148, 0
  v_mov_b32 v149, 0
  v_mov_b32 v150, 0
  v_mov_b32 v151, 0
  v_mov_b32 v152, 0
  v_mov_b32 v153, 0
  v_mov_b32 v154, 0
  v_mov_b32 v155, 0
  v_mov_b32 v156, 0
  v_mov_b32 v157, 0
  v_mov_b32 v158, 0
  v_mov_b32 v159, 0
  s_waitcnt lgkmcnt(0)
  s_mul_i32 s74, s74, 0x9E3779B1
  s_add_u32 s74, s74, 0x7F4A7C15
  s_barrier
  ds_read_b128 v[24:27], v10 offset:0
  ds_read_b64_tr_b16 v[32:33], v14 offset:0
  ds_read_b64_tr_b16 v[34:35], v14 offset:1024
  ds_read_b64_tr_b16 v[36:37], v15 offset:0
  ds_read_b64_tr_b16 v[38:39], v15 offset:1024
  ds_read_b128 v[28:31], v10 offset:4096
  s_waitcnt lgkmcnt(3)
  v_mfma_f32_32x32x16_bf16 v[64:79], v[24:27], v[32:35], v[64:79]
  ds_read_b128 v[40:43], v11 offset:0
  ds_read_b64_tr_b16 v[48:49], v14 offset:4096
  ds_read_b64_tr_b16 v[50:51], v14 offset:5120
  s_waitcnt lgkmcnt(4)
  v_mfma_f32_32x32x16_bf16 v[96:111], v[24:27], v[36:39], v[96:111]
  ds_read_b64_tr_b16 v[52:53], v15 offset:4096
  ds_read_b64_tr_b16 v[54:55], v15 offset:5120
  ds_read_b128 v[44:47], v11 offset:4096
  s_waitcnt lgkmcnt(6)
  v_mfma_f32_32x32x16_bf16 v[80:95], v[28:31], v[32:35], v[80:95]
  v_mfma_f32_32x32x16_bf16 v[112:127], v[28:31], v[36:39], v[112:127]
  s_waitcnt lgkmcnt(3)
  v_mfma_f32_32x32x16_bf16 v[64:79], v[40:43], v[48:51], v[64:79]
  ds_read_b128 v[24:27], v12 offset:0
  ds_read_b64_tr_b16 v[32:33], v14 offset:8192
  ds_read_b64_tr_b16 v[34:35], v14 offset:9216
  s_waitcnt lgkmcnt(4)
  v_mfma_f32_32x32x16_bf16 v[96:111], v[40:43], v[52:55], v[96:111]
  ds_read_b64_tr_b16 v[36:37], v15 offset:8192
  ds_read_b64_tr_b16 v[38:39], v15 offset:9216
  ds_read_b128 v[28:31], v12 offset:4096
  s_waitcnt lgkmcnt(6)
  v_mfma_f32_32x32x16_bf16 v[80:95], v[44:47], v[48:51], v[80:95]
  v_mfma_f32_32x32x16_bf16 v[112:127], v[44:47], v[52:55], v[112:127]
  s_waitcnt lgkmcnt(3)
  v_mfma_f32_32x32x16_bf16 v[64:79], v[24:27], v[32:35], v[64:79]
  ds_read_b128 v[40:43], v13 offset:0
  ds_read_b64_tr_b16 v[48:49], v14 offset:12288
  ds_read_b64_tr_b16 v[50:51], v14 offset:13312
  s_waitcnt lgkmcnt(4)
  v_mfma_f32_32x32x16_bf16 v[96:111], v[24:27], v[36:39], v[96:111]
  ds_read_b64_tr_b16 v[52:53], v15 offset:12288
  ds_read_b64_tr_b16 v[54:55], v15 offset:13312
  ds_read_b128 v[44:47], v13 offset:4096
  s_waitcnt lgkmcnt(6)
  v_mfma_f32_32x32x16_bf16 v[80:95], v[28:31], v[32:35], v[80:95]
  v_mfma_f32_32x32x16_bf16 v[112:127], v[28:31], v[36:39], v[112:127]
  s_waitcnt lgkmcnt(3)
  v_mfma_f32_32x32x16_bf16 v[64:79], v[40:43], v[48:51], v[64:79]
  s_waitcnt lgkmcnt(0)
  s_barrier
  ds_read_b128 v[24:27], v10 offset:16384
  ds_read_b64_tr_b16 v[32:33], v14 offset:16384
  ds_read_b64_tr_b16 v[34:35], v14 offset:17408
  v_mfma_f32_32x32x16_bf16 v[96:111], v[40:43], v[52:55], v[96:111]
  ds_read_b64_tr_b16 v[36:37], v15 offset:16384
  ds_read_b64_tr_b16 v[38:39], v15 offset:17408
  v_mfma_f32_32x32x16_bf16 v[80:95], v[44:47], v[48:51], v[80:95]
  ds_read_b128 v[28:31], v10 offset:20480
  v_mfma_f32_32x32x16_bf16 v[112:127], v[44:47], v[52:55], v[112:127]
  s_waitcnt lgkmcnt(3)
  v_mfma_f32_32x32x16_bf16 v[64:79], v[24:27], v[32:35], v[64:79]
  ds_read_b128 v[40:43], v11 offset:16384
  ds_read_b64_tr_b16 v[48:49], v14 offset:20480
  ds_read_b64_tr_b16 v[50:51], v14 offset:21504
  s_waitcnt lgkmcnt(4)
  v_mfma_f32_32x32x16_bf16 v[96:111], v[24:27], v[36:39], v[96:111]
  ds_read_b64_tr_b16 v[52:53], v15 offset:20480
  ds_read_b64_tr_b16 v[54:55], v15 offset:21504
  ds_read_b128 v[44:47], v11 offset:20480
  s_waitcnt lgkmcnt(6)
  v_mfma_f32_32x32x16_bf16 v[80:95], v[28:31], v[32:35], v[80:95]
  v_mfma_f32_32x32x16_bf16 v[112:127], v[28:31], v[36:39], v[112:127]
  s_waitcnt lgkmcnt(3)
  v_mfma_f32_32x32x16_bf16 v[64:79], v[40:43], v[48:51], v[64:79]
  ds_read_b128 v[24:27], v12 offset:16384
  ds_read_b64_tr_b16 v[32:33], v14 offset:24576
  ds_read_b64_tr_b16 v[34:35], v14 offset:25600
  s_waitcnt lgkmcnt(4)
  v_mfma_f32_32x32x16_bf16 v[96:111], v[40:43], v[52:55], v[96:111]
  ds_read_b64_tr_b16 v[36:37], v15 offset:24576
  ds_read_b64_tr_b16 v[38:39], v15 offset:25600
  ds_read_b128 v[28:31], v12 offset:20480
  s_waitcnt lgkmcnt(6)
  v_mfma_f32_32x32x16_bf16 v[80:95], v[44:47], v[48:51], v[80:95]
  v_mfma_f32_32x32x16_bf16 v[112:127], v[44:47], v[52:55], v[112:127]
  s_waitcnt lgkmcnt(3)
  v_mfma_f32_32x32x16_bf16 v[64:79], v[24:27], v[32:35], v[64:79]
  ds_read_b128 v[40:43], v13 offset:16384
  ds_read_b64_tr_b16 v[48:49], v14 offset:28672
  ds_read_b64_tr_b16 v[50:51], v14 offset:29696
  s_waitcnt lgkmcnt(4)
  v_mfma_f32_32x32x16_bf16 v[96:111], v[24:27], v[36:39], v[96:111]
  ds_read_b64_tr_b16 v[52:53], v15 offset:28672
  ds_read_b64_tr_b16 v[54:55], v15 offset:29696
  ds_read_b128 v[44:47], v13 offset:20480
  s_waitcnt lgkmcnt(6)
  v_mfma_f32_32x32x16_bf16 v[80:95], v[28:31], v[32:35], v[80:95]
  v_mfma_f32_32x32x16_bf16 v[112:127], v[28:31], v[36:39], v[112:127]
  s_waitcnt lgkmcnt(3)
  v_mfma_f32_32x32x16_bf16 v[64:79], v[40:43], v[48:51], v[64:79]
  s_waitcnt lgkmcnt(0)
  s_cmp_lg_u32 s30, 0
  s_cbranch_scc1 Lzw_21
  s_waitcnt vmcnt(0)
Lzw_21:
  s_barrier
  s_cmp_lg_u32 s30, 0
  s_cbranch_scc1 Lzp_22
  s_cmp_lg_u32 s28, 0
  s_cbranch_scc1 Lpub_23
  v_mov_b32 v7, s74
  v_mov_b32 v8, 0
  s_mov_b64 exec, 1
  buffer_store_dword v7, v8, s[44:47], s65 offen sc1
  s_mov_b64 exec, -1
Lpub_23:
Lzp_22:
  ds_read_b128 v[24:27], v10 offset:32768
  ds_read_b64_tr_b16 v[32:33], v14 offset:32768
  ds_read_b64_tr_b16 v[34:35], v14 offset:33792
  v_mfma_f32_32x32x16_bf16 v[96:111], v[40:43], v[52:55], v[96:111]
  ds_read_b64_tr_b16 v[36:37], v15 offset:32768
  ds_read_b64_tr_b16 v[38:39], v15 offset:33792
  v_mfma_f32_32x32x16_bf16 v[80:95], v[44:47], v[48:51], v[80:95]
  ds_read_b128 v[28:31], v10 offset:36864
  v_mfma_f32_32x32x16_bf16 v[112:127], v[44:47], v[52:55], v[112:127]
  s_waitcnt lgkmcnt(3)
  v_mfma_f32_32x32x16_bf16 v[64:79], v[24:27], v[32:35], v[64:79]
  ds_read_b128 v[40:43], v11 offset:32768
  ds_read_b64_tr_b16 v[48:49], v14 offset:36864
  ds_read_b64_tr_b16 v[50:51], v14 offset:37888
  s_waitcnt lgkmcnt(4)
  v_mfma_f32_32x32x16_bf16 v[96:111], v[24:27], v[36:39], v[96:111]
  ds_read_b64_tr_b16 v[52:53], v15 offset:36864
  ds_read_b64_tr_b16 v[54:55], v15 offset:37888
  ds_read_b128 v[44:47], v11 offset:36864
  s_waitcnt lgkmcnt(6)
  v_mfma_f32_32x32x16_bf16 v[80:95], v[28:31], v[32:35], v[80:95]
  v_mfma_f32_32x32x16_bf16 v[112:127], v[28:31], v[36:39], v[112:127]
  s_waitcnt lgkmcnt(3)
  v_mfma_f32_32x32x16_bf16 v[64:79], v[40:43], v[48:51], v[64:79]
  ds_read_b128 v[24:27], v12 offset:32768
  ds_read_b64_tr_b16 v[32:33], v14 offset:40960
  ds_read_b64_tr_b16 v[34:35], v14 offset:41984
  s_waitcnt lgkmcnt(4)
  v_mfma_f32_32x32x16_bf16 v[96:111], v[40:43], v[52:55], v[96:111]
  ds_read_b64_tr_b16 v[36:37], v15 offset:40960
  ds_read_b64_tr_b16 v[38:39], v15 offset:41984
  ds_read_b128 v[28:31], v12 offset:36864
  s_waitcnt lgkmcnt(6)
  v_mfma_f32_32x32x16_bf16 v[80:95], v[44:47], v[48:51], v[80:95]
  v_mfma_f32_32x32x16_bf16 v[112:127], v[44:47], v[52:55], v[112:127]
  s_waitcnt lgkmcnt(3)
  v_mfma_f32_32x32x16_bf16 v[64:79], v[24:27], v[32:35], v[64:79]
  ds_read_b128 v[40:43], v13 offset:32768
  ds_read_b64_tr_b16 v[48:49], v14 offset:45056
  ds_read_b64_tr_b16 v[50:51], v14 offset:46080
  s_waitcnt lgkmcnt(4)
  v_mfma_f32_32x32x16_bf16 v[96:111], v[24:27], v[36:39], v[96:111]
  ds_read_b64_tr_b16 v[52:53], v15 offset:45056
  ds_read_b64_tr_b16 v[54:55], v15 offset:46080
  ds_read_b128 v[44:47], v13 offset:36864
  s_waitcnt lgkmcnt(6)
  v_mfma_f32_32x32x16_bf16 v[80:95], v[28:31], v[32:35], v[80:95]
  v_mfma_f32_32x32x16_bf16 v[112:127], v[28:31], v[36:39], v[112:127]
  s_waitcnt lgkmcnt(3)
  v_mfma_f32_32x32x16_bf16 v[64:79], v[40:43], v[48:51], v[64:79]
  s_waitcnt lgkmcnt(0)
  s_barrier
  ds_read_b128 v[24:27], v10 offset:49152
  ds_read_b64_tr_b16 v[32:33], v14 offset:0
  ds_read_b64_tr_b16 v[34:35], v14 offset:1024
  v_mfma_f32_32x32x16_bf16 v[96:111], v[40:43], v[52:55], v[96:111]
  ds_read_b64_tr_b16 v[36:37], v15 offset:0
  ds_read_b64_tr_b16 v[38:39], v15 offset:1024
  v_mfma_f32_32x32x16_bf16 v[80:95], v[44:47], v[48:51], v[80:95]
  ds_read_b128 v[28:31], v10 offset:53248
  v_mfma_f32_32x32x16_bf16 v[112:127], v[44:47], v[52:55], v[112:127]
  s_waitcnt lgkmcnt(3)
  v_mfma_f32_32x32x16_bf16 v[64:79], v[24:27], v[32:35], v[64:79]
  ds_read_b128 v[40:43], v11 offset:49152
  ds_read_b64_tr_b16 v[48:49], v14 offset:4096
  ds_read_b64_tr_b16 v[50:51], v14 offset:5120
  s_waitcnt lgkmcnt(4)
  v_mfma_f32_32x32x16_bf16 v[96:111], v[24:27], v[36:39], v[96:111]
  ds_read_b64_tr_b16 v[52:53], v15 offset:4096
  ds_read_b64_tr_b16 v[54:55], v15 offset:5120
  ds_read_b128 v[44:47], v11 offset:53248
  s_waitcnt lgkmcnt(6)
  v_mfma_f32_32x32x16_bf16 v[80:95], v[28:31], v[32:35], v[80:95]
  v_mfma_f32_32x32x16_bf16 v[112:127], v[28:31], v[36:39], v[112:127]
  s_waitcnt lgkmcnt(3)
  v_mfma_f32_32x32x16_bf16 v[64:79], v[40:43], v[48:51], v[64:79]
  ds_read_b128 v[24:27], v12 offset:49152
  ds_read_b64_tr_b16 v[32:33], v14 offset:8192
  ds_read_b64_tr_b16 v[34:35], v14 offset:9216
  s_waitcnt lgkmcnt(4)
  v_mfma_f32_32x32x16_bf16 v[96:111], v[40:43], v[52:55], v[96:111]
  ds_read_b64_tr_b16 v[36:37], v15 offset:8192
  ds_read_b64_tr_b16 v[38:39], v15 offset:9216
  ds_read_b128 v[28:31], v12 offset:53248
  s_waitcnt lgkmcnt(6)
  v_mfma_f32_32x32x16_bf16 v[80:95], v[44:47], v[48:51], v[80:95]
  v_mfma_f32_32x32x16_bf16 v[112:127], v[44:47], v[52:55], v[112:127]
  s_waitcnt lgkmcnt(3)
  v_mfma_f32_32x32x16_bf16 v[64:79], v[24:27], v[32:35], v[64:79]
  ds_read_b128 v[40:43], v13 offset:49152
  ds_read_b64_tr_b16 v[48:49], v14 offset:12288
  ds_read_b64_tr_b16 v[50:51], v14 offset:13312
  s_waitcnt lgkmcnt(4)
  v_mfma_f32_32x32x16_bf16 v[96:111], v[24:27], v[36:39], v[96:111]
  ds_read_b64_tr_b16 v[52:53], v15 offset:12288
  ds_read_b64_tr_b16 v[54:55], v15 offset:13312
  ds_read_b128 v[44:47], v13 offset:53248
  s_waitcnt lgkmcnt(6)
  v_mfma_f32_32x32x16_bf16 v[80:95], v[28:31], v[32:35], v[80:95]
  v_mfma_f32_32x32x16_bf16 v[112:127], v[28:31], v[36:39], v[112:127]
  s_waitcnt lgkmcnt(3)
  v_mfma_f32_32x32x16_bf16 v[64:79], v[40:43], v[48:51], v[64:79]
  s_waitcnt lgkmcnt(0)
  s_barrier
  v_add_u32 v10, 65536, v10
  v_add_u32 v11, 65536, v11
  v_add_u32 v12, 65536, v12
  v_add_u32 v13, 65536, v13
  ds_read_b128 v[24:27], v10 offset:0
  ds_read_b64_tr_b16 v[32:33], v14 offset:16384
  ds_read_b64_tr_b16 v[34:35], v14 offset:17408
  v_mfma_f32_32x32x16_bf16 v[96:111], v[40:43], v[52:55], v[96:111]
  ds_read_b64_tr_b16 v[36:37], v15 offset:16384
  ds_read_b64_tr_b16 v[38:39], v15 offset:17408
  v_mfma_f32_32x32x16_bf16 v[80:95], v[44:47], v[48:51], v[80:95]
  ds_read_b128 v[28:31], v10 offset:4096
  v_mfma_f32_32x32x16_bf16 v[112:127], v[44:47], v[52:55], v[112:127]
  s_waitcnt lgkmcnt(3)
  v_mfma_f32_32x32x16_bf16 v[64:79], v[24:27], v[32:35], v[64:79]
  ds_read_b128 v[40:43], v11 offset:0
  ds_read_b64_tr_b16 v[48:49], v14 offset:20480
  ds_read_b64_tr_b16 v[50:51], v14 offset:21504
  s_waitcnt lgkmcnt(4)
  v_mfma_f32_32x32x16_bf16 v[96:111], v[24:27], v[36:39], v[96:111]
  ds_read_b64_tr_b16 v[52:53], v15 offset:20480
  ds_read_b64_tr_b16 v[54:55], v15 offset:21504
  ds_read_b128 v[44:47], v11 offset:4096
  s_waitcnt lgkmcnt(6)
  v_mfma_f32_32x32x16_bf16 v[80:95], v[28:31], v[32:35], v[80:95]
  v_mfma_f32_32x32x16_bf16 v[112:127], v[28:31], v[36:39], v[112:127]
  s_waitcnt lgkmcnt(3)
  v_mfma_f32_32x32x16_bf16 v[64:79], v[40:43], v[48:51], v[64:79]
  ds_read_b128 v[24:27], v12 offset:0
  ds_read_b64_tr_b16 v[32:33], v14 offset:24576
  ds_read_b64_tr_b16 v[34:35], v14 offset:25600
  s_waitcnt lgkmcnt(4)
  v_mfma_f32_32x32x16_bf16 v[96:111], v[40:43], v[52:55], v[96:111]
  ds_read_b64_tr_b16 v[36:37], v15 offset:24576
  ds_read_b64_tr_b16 v[38:39], v15 offset:25600
  ds_read_b128 v[28:31], v12 offset:4096
  s_waitcnt lgkmcnt(6)
  v_mfma_f32_32x32x16_bf16 v[80:95], v[44:47], v[48:51], v[80:95]
  v_mfma_f32_32x32x16_bf16 v[112:127], v[44:47], v[52:55], v[112:127]
  s_waitcnt lgkmcnt(3)
  v_mfma_f32_32x32x16_bf16 v[64:79], v[24:27], v[32:35], v[64:79]
  ds_read_b128 v[40:43], v13 offset:0
  ds_read_b64_tr_b16 v[48:49], v14 offset:28672
  ds_read_b64_tr_b16 v[50:51], v14 offset:29696
  s_waitcnt lgkmcnt(4)
  v_mfma_f32_32x32x16_bf16 v[96:111], v[24:27], v[36:39], v[96:111]
  ds_read_b64_tr_b16 v[52:53], v15 offset:28672
  ds_read_b64_tr_b16 v[54:55], v15 offset:29696
  ds_read_b128 v[44:47], v13 offset:4096
  s_waitcnt lgkmcnt(6)
  v_mfma_f32_32x32x16_bf16 v[80:95], v[28:31], v[32:35], v[80:95]
  v_mfma_f32_32x32x16_bf16 v[112:127], v[28:31], v[36:39], v[112:127]
  s_waitcnt lgkmcnt(3)
  v_mfma_f32_32x32x16_bf16 v[64:79], v[40:43], v[48:51], v[64:79]
  s_waitcnt lgkmcnt(0)
  s_barrier
  ds_read_b128 v[24:27], v10 offset:16384
  ds_read_b64_tr_b16 v[32:33], v14 offset:32768
  ds_read_b64_tr_b16 v[34:35], v14 offset:33792
  v_mfma_f32_32x32x16_bf16 v[96:111], v[40:43], v[52:55], v[96:111]
  ds_read_b64_tr_b16 v[36:37], v15 offset:32768
  ds_read_b64_tr_b16 v[38:39], v15 offset:33792
  v_mfma_f32_32x32x16_bf16 v[80:95], v[44:47], v[48:51], v[80:95]
  ds_read_b128 v[28:31], v10 offset:20480
  v_mfma_f32_32x32x16_bf16 v[112:127], v[44:47], v[52:55], v[112:127]
  s_waitcnt lgkmcnt(3)
  v_mfma_f32_32x32x16_bf16 v[64:79], v[24:27], v[32:35], v[64:79]
  ds_read_b128 v[40:43], v11 offset:16384
  ds_read_b64_tr_b16 v[48:49], v14 offset:36864
  ds_read_b64_tr_b16 v[50:51], v14 offset:37888
  s_waitcnt lgkmcnt(4)
  v_mfma_f32_32x32x16_bf16 v[96:111], v[24:27], v[36:39], v[96:111]
  ds_read_b64_tr_b16 v[52:53], v15 offset:36864
  ds_read_b64_tr_b16 v[54:55], v15 offset:37888
  ds_read_b128 v[44:47], v11 offset:20480
  s_waitcnt lgkmcnt(6)
  v_mfma_f32_32x32x16_bf16 v[80:95], v[28:31], v[32:35], v[80:95]
  v_mfma_f32_32x32x16_bf16 v[112:127], v[28:31], v[36:39], v[112:127]
  s_waitcnt lgkmcnt(3)
  v_mfma_f32_32x32x16_bf16 v[64:79], v[40:43], v[48:51], v[64:79]
  ds_read_b128 v[24:27], v12 offset:16384
  ds_read_b64_tr_b16 v[32:33], v14 offset:40960
  ds_read_b64_tr_b16 v[34:35], v14 offset:41984
  s_waitcnt lgkmcnt(4)
  v_mfma_f32_32x32x16_bf16 v[96:111], v[40:43], v[52:55], v[96:111]
  ds_read_b64_tr_b16 v[36:37], v15 offset:40960
  ds_read_b64_tr_b16 v[38:39], v15 offset:41984
  ds_read_b128 v[28:31], v12 offset:20480
  s_waitcnt lgkmcnt(6)
  v_mfma_f32_32x32x16_bf16 v[80:95], v[44:47], v[48:51], v[80:95]
  v_mfma_f32_32x32x16_bf16 v[112:127], v[44:47], v[52:55], v[112:127]
  s_waitcnt lgkmcnt(3)
  v_mfma_f32_32x32x16_bf16 v[64:79], v[24:27], v[32:35], v[64:79]
  ds_read_b128 v[40:43], v13 offset:16384
  ds_read_b64_tr_b16 v[48:49], v14 offset:45056
  ds_read_b64_tr_b16 v[50:51], v14 offset:46080
  s_waitcnt lgkmcnt(4)
  v_mfma_f32_32x32x16_bf16 v[96:111], v[24:27], v[36:39], v[96:111]
  ds_read_b64_tr_b16 v[52:53], v15 offset:45056
  ds_read_b64_tr_b16 v[54:55], v15 offset:46080
  ds_read_b128 v[44:47], v13 offset:20480
  s_waitcnt lgkmcnt(6)
  v_mfma_f32_32x32x16_bf16 v[80:95], v[28:31], v[32:35], v[80:95]
  v_mfma_f32_32x32x16_bf16 v[112:127], v[28:31], v[36:39], v[112:127]
  s_waitcnt lgkmcnt(3)
  v_mfma_f32_32x32x16_bf16 v[64:79], v[40:43], v[48:51], v[64:79]
  s_waitcnt lgkmcnt(0)
  s_barrier
  ds_read_b128 v[24:27], v10 offset:32768
  ds_read_b64_tr_b16 v[32:33], v14 offset:0
  ds_read_b64_tr_b16 v[34:35], v14 offset:1024
  v_mfma_f32_32x32x16_bf16 v[96:111], v[40:43], v[52:55], v[96:111]
  ds_read_b64_tr_b16 v[36:37], v15 offset:0
  ds_read_b64_tr_b16 v[38:39], v15 offset:1024
  v_mfma_f32_32x32x16_bf16 v[80:95], v[44:47], v[48:51], v[80:95]
  ds_read_b128 v[28:31], v10 offset:36864
  v_mfma_f32_32x32x16_bf16 v[112:127], v[44:47], v[52:55], v[112:127]
  v_mov_b32 v7, 0
  buffer_load_dword v23, v7, s[44:47], s65 offen sc1
  s_waitcnt lgkmcnt(3)
  v_mfma_f32_32x32x16_bf16 v[64:79], v[24:27], v[32:35], v[64:79]
  ds_read_b128 v[40:43], v11 offset:32768
  ds_read_b64_tr_b16 v[48:49], v14 offset:4096
  ds_read_b64_tr_b16 v[50:51], v14 offset:5120
  s_waitcnt lgkmcnt(4)
  v_mfma_f32_32x32x16_bf16 v[96:111], v[24:27], v[36:39], v[96:111]
  ds_read_b64_tr_b16 v[52:53], v15 offset:4096
  ds_read_b64_tr_b16 v[54:55], v15 offset:5120
  ds_read_b128 v[44:47], v11 offset:36864
  s_waitcnt lgkmcnt(6)
  v_mfma_f32_32x32x16_bf16 v[80:95], v[28:31], v[32:35], v[80:95]
  v_mfma_f32_32x32x16_bf16 v[112:127], v[28:31], v[36:39], v[112:127]
  s_waitcnt lgkmcnt(3)
  v_mfma_f32_32x32x16_bf16 v[64:79], v[40:43], v[48:51], v[64:79]
  ds_read_b128 v[24:27], v12 offset:32768
  ds_read_b64_tr_b16 v[32:33], v14 offset:8192
  ds_read_b64_tr_b16 v[34:35], v14 offset:9216
  s_waitcnt lgkmcnt(4)
  v_mfma_f32_32x32x16_bf16 v[96:111], v[40:43], v[52:55], v[96:111]
  ds_read_b64_tr_b16 v[36:37], v15 offset:8192
  ds_read_b64_tr_b16 v[38:39], v15 offset:9216
  ds_read_b128 v[28:31], v12 offset:36864
  s_waitcnt lgkmcnt(6)
  v_mfma_f32_32x32x16_bf16 v[80:95], v[44:47], v[48:51], v[80:95]
  v_mfma_f32_32x32x16_bf16 v[112:127], v[44:47], v[52:55], v[112:127]
  s_waitcnt lgkmcnt(3)
  v_mfma_f32_32x32x16_bf16 v[64:79], v[24:27], v[32:35], v[64:79]
  ds_read_b128 v[40:43], v13 offset:32768
  ds_read_b64_tr_b16 v[48:49], v14 offset:12288
  ds_read_b64_tr_b16 v[50:51], v14 offset:13312
  s_waitcnt lgkmcnt(4)
  v_mfma_f32_32x32x16_bf16 v[96:111], v[24:27], v[36:39], v[96:111]
  ds_read_b64_tr_b16 v[52:53], v15 offset:12288
  ds_read_b64_tr_b16 v[54:55], v15 offset:13312
  ds_read_b128 v[44:47], v13 offset:36864
  s_waitcnt lgkmcnt(6)
  v_mfma_f32_32x32x16_bf16 v[80:95], v[28:31], v[32:35], v[80:95]
  v_mfma_f32_32x32x16_bf16 v[112:127], v[28:31], v[36:39], v[112:127]
  s_waitcnt lgkmcnt(3)
  v_mfma_f32_32x32x16_bf16 v[64:79], v[40:43], v[48:51], v[64:79]
  s_waitcnt lgkmcnt(0)
  s_barrier
  buffer_load_dword v249, v248, s[52:55], s94 offen
  v_mfma_f32_32x32x16_bf16 v[96:111], v[40:43], v[52:55], v[96:111]
  v_mfma_f32_32x32x16_bf16 v[80:95], v[44:47], v[48:51], v[80:95]
  v_mfma_f32_32x32x16_bf16 v[112:127], v[44:47], v[52:55], v[112:127]
  s_nop 5
  v_mul_f32 v56, s70, v64
  v_mul_f32 v57, s70, v65
  v_mul_f32 v58, s70, v66
  v_mul_f32 v59, s70, v67
  v_exp_f32_e64 v56, v56 clamp
  v_exp_f32_e64 v57, v57 clamp
  v_exp_f32_e64 v58, v58 clamp
  v_exp_f32_e64 v59, v59 clamp
  v_max_f32 v64, 0, v64
  v_max_f32 v65, 0, v65
  v_max_f32 v66, 0, v66
  v_max_f32 v67, 0, v67
  v_add_f32 v64, v64, v56
  v_add_f32 v65, v65, v57
  v_add_f32 v66, v66, v58
  v_add_f32 v67, v67, v59
  v_add_f32 v64, s71, v64
  v_add_f32 v65, s71, v65
  v_add_f32 v66, s71, v66
  v_add_f32 v67, s71, v67
  v_mul_f32 v56, s70, v68
  v_mul_f32 v57, s70, v69
  v_mul_f32 v58, s70, v70
  v_mul_f32 v59, s70, v71
  v_exp_f32_e64 v56, v56 clamp
  v_exp_f32_e64 v57, v57 clamp
  v_exp_f32_e64 v58, v58 clamp
  v_exp_f32_e64 v59, v59 clamp
  v_max_f32 v68, 0, v68
  v_max_f32 v69, 0, v69
  v_max_f32 v70, 0, v70
  v_max_f32 v71, 0, v71
  v_add_f32 v68, v68, v56
  v_add_f32 v69, v69, v57
  v_add_f32 v70, v70, v58
  v_add_f32 v71, v71, v59
  v_add_f32 v68, s71, v68
  v_add_f32 v69, s71, v69
  v_add_f32 v70, s71, v70
  v_add_f32 v71, s71, v71
  v_mul_f32 v56, s70, v72
  v_mul_f32 v57, s70, v73
  v_mul_f32 v58, s70, v74
  v_mul_f32 v59, s70, v75
  v_exp_f32_e64 v56, v56 clamp
  v_exp_f32_e64 v57, v57 clamp
  v_exp_f32_e64 v58, v58 clamp
  v_exp_f32_e64 v59, v59 clamp
  v_max_f32 v72, 0, v72
  v_max_f32 v73, 0, v73
  v_max_f32 v74, 0, v74
  v_max_f32 v75, 0, v75
  v_add_f32 v72, v72, v56
  v_add_f32 v73, v73, v57
  v_add_f32 v74, v74, v58
  v_add_f32 v75, v75, v59
  v_add_f32 v72, s71, v72
  v_add_f32 v73, s71, v73
  v_add_f32 v74, s71, v74
  v_add_f32 v75, s71, v75
  v_mul_f32 v56, s70, v76
  v_mul_f32 v57, s70, v77
  v_mul_f32 v58, s70, v78
  v_mul_f32 v59, s70, v79
  v_exp_f32_e64 v56, v56 clamp
  v_exp_f32_e64 v57, v57 clamp
  v_exp_f32_e64 v58, v58 clamp
  v_exp_f32_e64 v59, v59 clamp
  v_max_f32 v76, 0, v76
  v_max_f32 v77, 0, v77
  v_max_f32 v78, 0, v78
  v_max_f32 v79, 0, v79
  v_add_f32 v76, v76, v56
  v_add_f32 v77, v77, v57
  v_add_f32 v78, v78, v58
  v_add_f32 v79, v79, v59
  v_add_f32 v76, s71, v76
  v_add_f32 v77, s71, v77
  v_add_f32 v78, s71, v78
  v_add_f32 v79, s71, v79
  v_cvt_pk_bf16_f32 v176, v64, v65
  v_cvt_pk_bf16_f32 v177, v66, v67
  v_cvt_pk_bf16_f32 v178, v68, v69
  v_cvt_pk_bf16_f32 v179, v70, v71
  v_cvt_pk_bf16_f32 v180, v72, v73
  v_cvt_pk_bf16_f32 v181, v74, v75
  v_cvt_pk_bf16_f32 v182, v76, v77
  v_cvt_pk_bf16_f32 v183, v78, v79
  v_mul_f32 v56, s70, v80
  v_mul_f32 v57, s70, v81
  v_mul_f32 v58, s70, v82
  v_mul_f32 v59, s70, v83
  v_exp_f32_e64 v56, v56 clamp
  v_exp_f32_e64 v57, v57 clamp
  v_exp_f32_e64 v58, v58 clamp
  v_exp_f32_e64 v59, v59 clamp
  v_max_f32 v80, 0, v80
  v_max_f32 v81, 0, v81
  v_max_f32 v82, 0, v82
  v_max_f32 v83, 0, v83
  v_add_f32 v80, v80, v56
  v_add_f32 v81, v81, v57
  v_add_f32 v82, v82, v58
  v_add_f32 v83, v83, v59
  v_add_f32 v80, s71, v80
  v_add_f32 v81, s71, v81
  v_add_f32 v82, s71, v82
  v_add_f32 v83, s71, v83
  v_mul_f32 v56, s70, v84
  v_mul_f32 v57, s70, v85
  v_mul_f32 v58, s70, v86
  v_mul_f32 v59, s70, v87
  v_exp_f32_e64 v56, v56 clamp
  v_exp_f32_e64 v57, v57 clamp
  v_exp_f32_e64 v58, v58 clamp
  v_exp_f32_e64 v59, v59 clamp
  v_max_f32 v84, 0, v84
  v_max_f32 v85, 0, v85
  v_max_f32 v86, 0, v86
  v_max_f32 v87, 0, v87
  v_add_f32 v84, v84, v56
  v_add_f32 v85, v85, v57
  v_add_f32 v86, v86, v58
  v_add_f32 v87, v87, v59
  v_add_f32 v84, s71, v84
  v_add_f32 v85, s71, v85
  v_add_f32 v86, s71, v86
  v_add_f32 v87, s71, v87
  v_mul_f32 v56, s70, v88
  v_mul_f32 v57, s70, v89
  v_mul_f32 v58, s70, v90
  v_mul_f32 v59, s70, v91
  v_exp_f32_e64 v56, v56 clamp
  v_exp_f32_e64 v57, v57 clamp
  v_exp_f32_e64 v58, v58 clamp
  v_exp_f32_e64 v59, v59 clamp
  v_max_f32 v88, 0, v88
  v_max_f32 v89, 0, v89
  v_max_f32 v90, 0, v90
  v_max_f32 v91, 0, v91
  v_add_f32 v88, v88, v56
  v_add_f32 v89, v89, v57
  v_add_f32 v90, v90, v58
  v_add_f32 v91, v91, v59
  v_add_f32 v88, s71, v88
  v_add_f32 v89, s71, v89
  v_add_f32 v90, s71, v90
  v_add_f32 v91, s71, v91
  v_mul_f32 v56, s70, v92
  v_mul_f32 v57, s70, v93
  v_mul_f32 v58, s70, v94
  v_mul_f32 v59, s70, v95
  v_exp_f32_e64 v56, v56 clamp
  v_exp_f32_e64 v57, v57 clamp
  v_exp_f32_e64 v58, v58 clamp
  v_exp_f32_e64 v59, v59 clamp
  v_max_f32 v92, 0, v92
  v_max_f32 v93, 0, v93
  v_max_f32 v94, 0, v94
  v_max_f32 v95, 0, v95
  v_add_f32 v92, v92, v56
  v_add_f32 v93, v93, v57
  v_add_f32 v94, v94, v58
  v_add_f32 v95, v95, v59
  v_add_f32 v92, s71, v92
  v_add_f32 v93, s71, v93
  v_add_f32 v94, s71, v94
  v_add_f32 v95, s71, v95
  v_cvt_pk_bf16_f32 v184, v80, v81
  v_cvt_pk_bf16_f32 v185, v82, v83
  v_cvt_pk_bf16_f32 v186, v84, v85
  v_cvt_pk_bf16_f32 v187, v86, v87
  v_cvt_pk_bf16_f32 v188, v88, v89
  v_cvt_pk_bf16_f32 v189, v90, v91
  v_cvt_pk_bf16_f32 v190, v92, v93
  v_cvt_pk_bf16_f32 v191, v94, v95
  v_cmp_eq_u32 vcc, 28, v2
  v_mov_b32 v7, 0x3f803f80
  v_cvt_pk_bf16_f32 v192, v96, v97
  v_cvt_pk_bf16_f32 v193, v98, v99
  v_cvt_pk_bf16_f32 v194, v100, v101
  v_cvt_pk_bf16_f32 v195, v102, v103
  v_cvt_pk_bf16_f32 v196, v104, v105
  v_cvt_pk_bf16_f32 v197, v106, v107
  v_cvt_pk_bf16_f32 v198, v108, v109
  v_cvt_pk_bf16_f32 v199, v110, v111
  v_cndmask_b32 v192, v192, v7, vcc
  v_cndmask_b32 v193, v193, v7, vcc
  v_cndmask_b32 v194, v194, v7, vcc
  v_cndmask_b32 v195, v195, v7, vcc
  v_cndmask_b32 v196, v196, v7, vcc
  v_cndmask_b32 v197, v197, v7, vcc
  v_cndmask_b32 v198, v198, v7, vcc
  v_cndmask_b32 v199, v199, v7, vcc
  v_cvt_pk_bf16_f32 v200, v112, v113
  v_cvt_pk_bf16_f32 v201, v114, v115
  v_cvt_pk_bf16_f32 v202, v116, v117
  v_cvt_pk_bf16_f32 v203, v118, v119
  v_cvt_pk_bf16_f32 v204, v120, v121
  v_cvt_pk_bf16_f32 v205, v122, v123
  v_cvt_pk_bf16_f32 v206, v124, v125
  v_cvt_pk_bf16_f32 v207, v126, v127
  v_cndmask_b32 v200, v200, v7, vcc
  v_cndmask_b32 v201, v201, v7, vcc
  v_cndmask_b32 v202, v202, v7, vcc
  v_cndmask_b32 v203, v203, v7, vcc
  v_cndmask_b32 v204, v204, v7, vcc
  v_cndmask_b32 v205, v205, v7, vcc
  v_cndmask_b32 v206, v206, v7, vcc
  v_cndmask_b32 v207, v207, v7, vcc
  v_mfma_f32_32x32x16_bf16 v[160:175], v[176:179], v[192:195], 0
  v_mfma_f32_32x32x16_bf16 v[160:175], v[180:183], v[196:199], v[160:175]
  v_mfma_f32_32x32x16_bf16 v[160:175], v[184:187], v[200:203], v[160:175]
  v_mfma_f32_32x32x16_bf16 v[160:175], v[188:191], v[204:207], v[160:175]
  s_lshl_b32 s35, s61, 12
  s_add_u32 s35, s35, 122880
  v_add_u32 v7, s35, v19
  s_cmp_eq_u32 s60, 0
  s_cbranch_scc1 La_24
  s_nop 7
  s_nop 3
  ds_write_b128 v7, v[160:163] offset:0
  ds_write_b128 v7, v[164:167] offset:1024
  ds_write_b128 v7, v[168:171] offset:2048
  ds_write_b128 v7, v[172:175] offset:3072
  s_waitcnt lgkmcnt(0)
La_24:
  s_barrier
  s_cmp_eq_u32 s60, 0
  s_cbranch_scc0 La_25
  ds_read_b128 v[176:179], v7 offset:0
  ds_read_b128 v[180:183], v7 offset:1024
  ds_read_b128 v[184:187], v7 offset:2048
  ds_read_b128 v[188:191], v7 offset:3072
  s_waitcnt vmcnt(0)
  v_cmp_ne_u32 vcc, s74, v23
  s_cbranch_vccz Lzok_26
  v_mov_b32 v8, 0
  s_mov_b32 s95, 0x8000
Lpoll_27:
  buffer_load_dword v23, v8, s[44:47], s65 offen sc1
  s_waitcnt vmcnt(0)
  v_cmp_ne_u32 vcc, s74, v23
  s_cbranch_vccz Lpdone_28
  s_sleep 1
  s_sub_u32 s95, s95, 1
  s_cmp_lg_u32 s95, 0
  s_cbranch_scc1 Lpoll_27
Lpdone_28:
Lzok_26:
  s_waitcnt lgkmcnt(0)
  s_nop 7
  v_add_f32 v160, v160, v176
  v_add_f32 v161, v161, v177
  v_add_f32 v162, v162, v178
  v_add_f32 v163, v163, v179
  v_add_f32 v164, v164, v180
  v_add_f32 v165, v165, v181
  v_add_f32 v166, v166, v182
  v_add_f32 v167, v167, v183
  v_add_f32 v168, v168, v184
  v_add_f32 v169, v169, v185
  v_add_f32 v170, v170, v186
  v_add_f32 v171, v171, v187
  v_add_f32 v172, v172, v188
  v_add_f32 v173, v173, v189
  v_add_f32 v174, v174, v190
  v_add_f32 v175, v175, v191
  s_lshl_b32 s35, s61, 12
  s_add_u32 s35, s35, s63
  buffer_atomic_add_f32 v160, v18, s[44:47], s35 offen offset:0
  buffer_atomic_add_f32 v161, v18, s[44:47], s35 offen offset:256
  buffer_atomic_add_f32 v162, v18, s[44:47], s35 offen offset:512
  buffer_atomic_add_f32 v163, v18, s[44:47], s35 offen offset:768
  buffer_atomic_add_f32 v164, v18, s[44:47], s35 offen offset:1024
  buffer_atomic_add_f32 v165, v18, s[44:47], s35 offen offset:1280
  buffer_atomic_add_f32 v166, v18, s[44:47], s35 offen offset:1536
  buffer_atomic_add_f32 v167, v18, s[44:47], s35 offen offset:1792
  buffer_atomic_add_f32 v168, v18, s[44:47], s35 offen offset:2048
  buffer_atomic_add_f32 v169, v18, s[44:47], s35 offen offset:2304
  buffer_atomic_add_f32 v170, v18, s[44:47], s35 offen offset:2560
  buffer_atomic_add_f32 v171, v18, s[44:47], s35 offen offset:2816
  buffer_atomic_add_f32 v172, v18, s[44:47], s35 offen offset:3072
  buffer_atomic_add_f32 v173, v18, s[44:47], s35 offen offset:3328
  buffer_atomic_add_f32 v174, v18, s[44:47], s35 offen offset:3584
  buffer_atomic_add_f32 v175, v18, s[44:47], s35 offen offset:3840
La_25:
  v_add_u32 v10, s62, v10
  v_add_u32 v11, s62, v11
  v_add_u32 v12, s62, v12
  v_add_u32 v13, s62, v13
  v_subrev_u32 v10, 65536, v10
  v_subrev_u32 v11, 65536, v11
  v_subrev_u32 v12, 65536, v12
  v_subrev_u32 v13, 65536, v13
  ds_read_b128 v[24:27], v10 offset:0
  ds_read_b64_tr_b16 v[28:29], v16 offset:16384
  ds_read_b64_tr_b16 v[30:31], v16 offset:16896
  ds_read_b64_tr_b16 v[32:33], v17 offset:16384
  ds_read_b64_tr_b16 v[34:35], v17 offset:16896
  ds_read_b128 v[36:39], v11 offset:0
  ds_read_b64_tr_b16 v[40:41], v16 offset:18432
  ds_read_b64_tr_b16 v[42:43], v16 offset:18944
  ds_read_b64_tr_b16 v[44:45], v17 offset:18432
  ds_read_b64_tr_b16 v[46:47], v17 offset:18944
  s_waitcnt lgkmcnt(7)
  v_mfma_f32_32x32x16_bf16 v[128:143], v[28:31], v[24:27], v[128:143]
  ds_read_b128 v[48:51], v12 offset:0
  ds_read_b64_tr_b16 v[52:53], v16 offset:20480
  ds_read_b64_tr_b16 v[54:55], v16 offset:20992
  s_waitcnt lgkmcnt(8)
  v_mfma_f32_32x32x16_bf16 v[144:159], v[32:35], v[24:27], v[144:159]
  ds_read_b64_tr_b16 v[56:57], v17 offset:20480
  ds_read_b64_tr_b16 v[58:59], v17 offset:20992
  ds_read_b128 v[60:63], v13 offset:0
  s_waitcnt lgkmcnt(8)
  v_mfma_f32_32x32x16_bf16 v[128:143], v[40:43], v[36:39], v[128:143]
  ds_read_b64_tr_b16 v[64:65], v16 offset:22528
  ds_read_b64_tr_b16 v[66:67], v16 offset:23040
  s_waitcnt lgkmcnt(8)
  v_mfma_f32_32x32x16_bf16 v[144:159], v[44:47], v[36:39], v[144:159]
  ds_read_b64_tr_b16 v[68:69], v17 offset:22528
  ds_read_b64_tr_b16 v[70:71], v17 offset:23040
  s_waitcnt lgkmcnt(7)
  v_mfma_f32_32x32x16_bf16 v[128:143], v[52:55], v[48:51], v[128:143]
  s_waitcnt lgkmcnt(0)
  s_barrier
  ds_read_b128 v[24:27], v10 offset:16384
  ds_read_b64_tr_b16 v[28:29], v16 offset:32768
  ds_read_b64_tr_b16 v[30:31], v16 offset:33280
  ds_read_b64_tr_b16 v[32:33], v17 offset:32768
  v_mfma_f32_32x32x16_bf16 v[144:159], v[56:59], v[48:51], v[144:159]
  ds_read_b64_tr_b16 v[34:35], v17 offset:33280
  ds_read_b128 v[36:39], v11 offset:16384
  ds_read_b64_tr_b16 v[40:41], v16 offset:34816
  v_mfma_f32_32x32x16_bf16 v[128:143], v[64:67], v[60:63], v[128:143]
  ds_read_b64_tr_b16 v[42:43], v16 offset:35328
  ds_read_b64_tr_b16 v[44:45], v17 offset:34816
  ds_read_b64_tr_b16 v[46:47], v17 offset:35328
  v_mfma_f32_32x32x16_bf16 v[144:159], v[68:71], v[60:63], v[144:159]
  s_waitcnt lgkmcnt(7)
  v_mfma_f32_32x32x16_bf16 v[128:143], v[28:31], v[24:27], v[128:143]
  ds_read_b128 v[48:51], v12 offset:16384
  ds_read_b64_tr_b16 v[52:53], v16 offset:36864
  ds_read_b64_tr_b16 v[54:55], v16 offset:37376
  s_waitcnt lgkmcnt(8)
  v_mfma_f32_32x32x16_bf16 v[144:159], v[32:35], v[24:27], v[144:159]
  ds_read_b64_tr_b16 v[56:57], v17 offset:36864
  ds_read_b64_tr_b16 v[58:59], v17 offset:37376
  ds_read_b128 v[60:63], v13 offset:16384
  s_waitcnt lgkmcnt(8)
  v_mfma_f32_32x32x16_bf16 v[128:143], v[40:43], v[36:39], v[128:143]
  ds_read_b64_tr_b16 v[64:65], v16 offset:38912
  ds_read_b64_tr_b16 v[66:67], v16 offset:39424
  s_waitcnt lgkmcnt(8)
  v_mfma_f32_32x32x16_bf16 v[144:159], v[44:47], v[36:39], v[144:159]
  ds_read_b64_tr_b16 v[68:69], v17 offset:38912
  ds_read_b64_tr_b16 v[70:71], v17 offset:39424
  s_waitcnt lgkmcnt(7)
  v_mfma_f32_32x32x16_bf16 v[128:143], v[52:55], v[48:51], v[128:143]
  s_waitcnt lgkmcnt(0)
  s_barrier
  ds_read_b128 v[24:27], v10 offset:32768
  ds_read_b64_tr_b16 v[28:29], v16 offset:0
  ds_read_b64_tr_b16 v[30:31], v16 offset:512
  ds_read_b64_tr_b16 v[32:33], v17 offset:0
  v_mfma_f32_32x32x16_bf16 v[144:159], v[56:59], v[48:51], v[144:159]
  ds_read_b64_tr_b16 v[34:35], v17 offset:512
  ds_read_b128 v[36:39], v11 offset:32768
  ds_read_b64_tr_b16 v[40:41], v16 offset:2048
  v_mfma_f32_32x32x16_bf16 v[128:143], v[64:67], v[60:63], v[128:143]
  ds_read_b64_tr_b16 v[42:43], v16 offset:2560
  ds_read_b64_tr_b16 v[44:45], v17 offset:2048
  ds_read_b64_tr_b16 v[46:47], v17 offset:2560
  v_mfma_f32_32x32x16_bf16 v[144:159], v[68:71], v[60:63], v[144:159]
  s_waitcnt lgkmcnt(7)
  v_mfma_f32_32x32x16_bf16 v[128:143], v[28:31], v[24:27], v[128:143]
  ds_read_b128 v[48:51], v12 offset:32768
  ds_read_b64_tr_b16 v[52:53], v16 offset:4096
  ds_read_b64_tr_b16 v[54:55], v16 offset:4608
  s_waitcnt lgkmcnt(8)
  v_mfma_f32_32x32x16_bf16 v[144:159], v[32:35], v[24:27], v[144:159]
  ds_read_b64_tr_b16 v[56:57], v17 offset:4096
  ds_read_b64_tr_b16 v[58:59], v17 offset:4608
  ds_read_b128 v[60:63], v13 offset:32768
  s_waitcnt lgkmcnt(8)
  v_mfma_f32_32x32x16_bf16 v[128:143], v[40:43], v[36:39], v[128:143]
  ds_read_b64_tr_b16 v[64:65], v16 offset:6144
  ds_read_b64_tr_b16 v[66:67], v16 offset:6656
  s_waitcnt lgkmcnt(8)
  v_mfma_f32_32x32x16_bf16 v[144:159], v[44:47], v[36:39], v[144:159]
  ds_read_b64_tr_b16 v[68:69], v17 offset:6144
  ds_read_b64_tr_b16 v[70:71], v17 offset:6656
  s_waitcnt lgkmcnt(7)
  v_mfma_f32_32x32x16_bf16 v[128:143], v[52:55], v[48:51], v[128:143]
  s_waitcnt lgkmcnt(0)
  s_barrier
  ds_read_b128 v[24:27], v10 offset:49152
  ds_read_b64_tr_b16 v[28:29], v16 offset:16384
  ds_read_b64_tr_b16 v[30:31], v16 offset:16896
  ds_read_b64_tr_b16 v[32:33], v17 offset:16384
  v_mfma_f32_32x32x16_bf16 v[144:159], v[56:59], v[48:51], v[144:159]
  ds_read_b64_tr_b16 v[34:35], v17 offset:16896
  ds_read_b128 v[36:39], v11 offset:49152
  ds_read_b64_tr_b16 v[40:41], v16 offset:18432
  v_mfma_f32_32x32x16_bf16 v[128:143], v[64:67], v[60:63], v[128:143]
  ds_read_b64_tr_b16 v[42:43], v16 offset:18944
  ds_read_b64_tr_b16 v[44:45], v17 offset:18432
  ds_read_b64_tr_b16 v[46:47], v17 offset:18944
  v_mfma_f32_32x32x16_bf16 v[144:159], v[68:71], v[60:63], v[144:159]
  s_waitcnt lgkmcnt(7)
  v_mfma_f32_32x32x16_bf16 v[128:143], v[28:31], v[24:27], v[128:143]
  ds_read_b128 v[48:51], v12 offset:49152
  ds_read_b64_tr_b16 v[52:53], v16 offset:20480
  ds_read_b64_tr_b16 v[54:55], v16 offset:20992
  s_waitcnt lgkmcnt(8)
  v_mfma_f32_32x32x16_bf16 v[144:159], v[32:35], v[24:27], v[144:159]
  ds_read_b64_tr_b16 v[56:57], v17 offset:20480
  ds_read_b64_tr_b16 v[58:59], v17 offset:20992
  ds_read_b128 v[60:63], v13 offset:49152
  s_waitcnt lgkmcnt(8)
  v_mfma_f32_32x32x16_bf16 v[128:143], v[40:43], v[36:39], v[128:143]
  ds_read_b64_tr_b16 v[64:65], v16 offset:22528
  ds_read_b64_tr_b16 v[66:67], v16 offset:23040
  s_waitcnt lgkmcnt(8)
  v_mfma_f32_32x32x16_bf16 v[144:159], v[44:47], v[36:39], v[144:159]
  ds_read_b64_tr_b16 v[68:69], v17 offset:22528
  ds_read_b64_tr_b16 v[70:71], v17 offset:23040
  s_waitcnt lgkmcnt(7)
  v_mfma_f32_32x32x16_bf16 v[128:143], v[52:55], v[48:51], v[128:143]
  s_waitcnt lgkmcnt(0)
  s_barrier
  v_add_u32 v10, 65536, v10
  v_add_u32 v11, 65536, v11
  v_add_u32 v12, 65536, v12
  v_add_u32 v13, 65536, v13
  ds_read_b128 v[24:27], v10 offset:0
  ds_read_b64_tr_b16 v[28:29], v16 offset:32768
  ds_read_b64_tr_b16 v[30:31], v16 offset:33280
  ds_read_b64_tr_b16 v[32:33], v17 offset:32768
  v_mfma_f32_32x32x16_bf16 v[144:159], v[56:59], v[48:51], v[144:159]
  ds_read_b64_tr_b16 v[34:35], v17 offset:33280
  ds_read_b128 v[36:39], v11 offset:0
  ds_read_b64_tr_b16 v[40:41], v16 offset:34816
  v_mfma_f32_32x32x16_bf16 v[128:143], v[64:67], v[60:63], v[128:143]
  ds_read_b64_tr_b16 v[42:43], v16 offset:35328
  ds_read_b64_tr_b16 v[44:45], v17 offset:34816
  ds_read_b64_tr_b16 v[46:47], v17 offset:35328
  v_mfma_f32_32x32x16_bf16 v[144:159], v[68:71], v[60:63], v[144:159]
  s_waitcnt lgkmcnt(7)
  v_mfma_f32_32x32x16_bf16 v[128:143], v[28:31], v[24:27], v[128:143]
  ds_read_b128 v[48:51], v12 offset:0
  ds_read_b64_tr_b16 v[52:53], v16 offset:36864
  ds_read_b64_tr_b16 v[54:55], v16 offset:37376
  s_waitcnt lgkmcnt(8)
  v_mfma_f32_32x32x16_bf16 v[144:159], v[32:35], v[24:27], v[144:159]
  ds_read_b64_tr_b16 v[56:57], v17 offset:36864
  ds_read_b64_tr_b16 v[58:59], v17 offset:37376
  ds_read_b128 v[60:63], v13 offset:0
  s_waitcnt lgkmcnt(8)
  v_mfma_f32_32x32x16_bf16 v[128:143], v[40:43], v[36:39], v[128:143]
  ds_read_b64_tr_b16 v[64:65], v16 offset:38912
  ds_read_b64_tr_b16 v[66:67], v16 offset:39424
  s_waitcnt lgkmcnt(8)
  v_mfma_f32_32x32x16_bf16 v[144:159], v[44:47], v[36:39], v[144:159]
  ds_read_b64_tr_b16 v[68:69], v17 offset:38912
  ds_read_b64_tr_b16 v[70:71], v17 offset:39424
  s_waitcnt lgkmcnt(7)
  v_mfma_f32_32x32x16_bf16 v[128:143], v[52:55], v[48:51], v[128:143]
  s_waitcnt lgkmcnt(0)
  s_waitcnt vmcnt(0)
  s_barrier
  s_cmp_lg_u32 s28, 0
  s_cbranch_scc1 Lpub_29
  v_mov_b32 v7, s74
  v_mov_b32 v8, 0
  s_mov_b64 exec, 1
  buffer_store_dword v7, v8, s[44:47], s81 offen sc1
  s_mov_b64 exec, -1
Lpub_29:
  ds_read_b128 v[24:27], v10 offset:16384
  ds_read_b64_tr_b16 v[28:29], v16 offset:0
  ds_read_b64_tr_b16 v[30:31], v16 offset:512
  ds_read_b64_tr_b16 v[32:33], v17 offset:0
  v_mfma_f32_32x32x16_bf16 v[144:159], v[56:59], v[48:51], v[144:159]
  ds_read_b64_tr_b16 v[34:35], v17 offset:512
  ds_read_b128 v[36:39], v11 offset:16384
  ds_read_b64_tr_b16 v[40:41], v16 offset:2048
  v_mfma_f32_32x32x16_bf16 v[128:143], v[64:67], v[60:63], v[128:143]
  ds_read_b64_tr_b16 v[42:43], v16 offset:2560
  ds_read_b64_tr_b16 v[44:45], v17 offset:2048
  ds_read_b64_tr_b16 v[46:47], v17 offset:2560
  v_mfma_f32_32x32x16_bf16 v[144:159], v[68:71], v[60:63], v[144:159]
  s_waitcnt lgkmcnt(7)
  v_mfma_f32_32x32x16_bf16 v[128:143], v[28:31], v[24:27], v[128:143]
  ds_read_b128 v[48:51], v12 offset:16384
  ds_read_b64_tr_b16 v[52:53], v16 offset:4096
  ds_read_b64_tr_b16 v[54:55], v16 offset:4608
  s_waitcnt lgkmcnt(8)
  v_mfma_f32_32x32x16_bf16 v[144:159], v[32:35], v[24:27], v[144:159]
  ds_read_b64_tr_b16 v[56:57], v17 offset:4096
  ds_read_b64_tr_b16 v[58:59], v17 offset:4608
  ds_read_b128 v[60:63], v13 offset:16384
  s_waitcnt lgkmcnt(8)
  v_mfma_f32_32x32x16_bf16 v[128:143], v[40:43], v[36:39], v[128:143]
  ds_read_b64_tr_b16 v[64:65], v16 offset:6144
  ds_read_b64_tr_b16 v[66:67], v16 offset:6656
  s_waitcnt lgkmcnt(8)
  v_mfma_f32_32x32x16_bf16 v[144:159], v[44:47], v[36:39], v[144:159]
  ds_read_b64_tr_b16 v[68:69], v17 offset:6144
  ds_read_b64_tr_b16 v[70:71], v17 offset:6656
  s_waitcnt lgkmcnt(7)
  v_mfma_f32_32x32x16_bf16 v[128:143], v[52:55], v[48:51], v[128:143]
  s_waitcnt lgkmcnt(0)
  s_barrier
  ds_read_b128 v[24:27], v10 offset:32768
  ds_read_b64_tr_b16 v[28:29], v16 offset:16384
  ds_read_b64_tr_b16 v[30:31], v16 offset:16896
  ds_read_b64_tr_b16 v[32:33], v17 offset:16384
  v_mfma_f32_32x32x16_bf16 v[144:159], v[56:59], v[48:51], v[144:159]
  ds_read_b64_tr_b16 v[34:35], v17 offset:16896
  ds_read_b128 v[36:39], v11 offset:32768
  ds_read_b64_tr_b16 v[40:41], v16 offset:18432
  v_mfma_f32_32x32x16_bf16 v[128:143], v[64:67], v[60:63], v[128:143]
  ds_read_b64_tr_b16 v[42:43], v16 offset:18944
  ds_read_b64_tr_b16 v[44:45], v17 offset:18432
  ds_read_b64_tr_b16 v[46:47], v17 offset:18944
  v_mfma_f32_32x32x16_bf16 v[144:159], v[68:71], v[60:63], v[144:159]
  s_waitcnt lgkmcnt(7)
  v_mfma_f32_32x32x16_bf16 v[128:143], v[28:31], v[24:27], v[128:143]
  ds_read_b128 v[48:51], v12 offset:32768
  ds_read_b64_tr_b16 v[52:53], v16 offset:20480
  ds_read_b64_tr_b16 v[54:55], v16 offset:20992
  s_waitcnt lgkmcnt(8)
  v_mfma_f32_32x32x16_bf16 v[144:159], v[32:35], v[24:27], v[144:159]
  ds_read_b64_tr_b16 v[56:57], v17 offset:20480
  ds_read_b64_tr_b16 v[58:59], v17 offset:20992
  ds_read_b128 v[60:63], v13 offset:32768
  s_waitcnt lgkmcnt(8)
  v_mfma_f32_32x32x16_bf16 v[128:143], v[40:43], v[36:39], v[128:143]
  ds_read_b64_tr_b16 v[64:65], v16 offset:22528
  ds_read_b64_tr_b16 v[66:67], v16 offset:23040
  s_waitcnt lgkmcnt(8)
  v_mfma_f32_32x32x16_bf16 v[144:159], v[44:47], v[36:39], v[144:159]
  ds_read_b64_tr_b16 v[68:69], v17 offset:22528
  ds_read_b64_tr_b16 v[70:71], v17 offset:23040
  s_waitcnt lgkmcnt(7)
  v_mfma_f32_32x32x16_bf16 v[128:143], v[52:55], v[48:51], v[128:143]
  s_waitcnt lgkmcnt(0)
  s_barrier
  v_mfma_f32_32x32x16_bf16 v[144:159], v[56:59], v[48:51], v[144:159]
  v_mfma_f32_32x32x16_bf16 v[128:143], v[64:67], v[60:63], v[128:143]
  v_mfma_f32_32x32x16_bf16 v[144:159], v[68:71], v[60:63], v[144:159]
  s_nop 10
  v_mul_f32 v56, s70, v128
  v_mul_f32 v57, s70, v129
  v_mul_f32 v58, s70, v130
  v_mul_f32 v59, s70, v131
  v_exp_f32_e64 v56, v56 clamp
  v_exp_f32_e64 v57, v57 clamp
  v_exp_f32_e64 v58, v58 clamp
  v_exp_f32_e64 v59, v59 clamp
  v_max_f32 v128, 0, v128
  v_max_f32 v129, 0, v129
  v_max_f32 v130, 0, v130
  v_max_f32 v131, 0, v131
  v_add_f32 v128, v128, v56
  v_add_f32 v129, v129, v57
  v_add_f32 v130, v130, v58
  v_add_f32 v131, v131, v59
  v_add_f32 v128, s71, v128
  v_add_f32 v129, s71, v129
  v_add_f32 v130, s71, v130
  v_add_f32 v131, s71, v131
  v_mul_f32 v56, s70, v132
  v_mul_f32 v57, s70, v133
  v_mul_f32 v58, s70, v134
  v_mul_f32 v59, s70, v135
  v_exp_f32_e64 v56, v56 clamp
  v_exp_f32_e64 v57, v57 clamp
  v_exp_f32_e64 v58, v58 clamp
  v_exp_f32_e64 v59, v59 clamp
  v_max_f32 v132, 0, v132
  v_max_f32 v133, 0, v133
  v_max_f32 v134, 0, v134
  v_max_f32 v135, 0, v135
  v_add_f32 v132, v132, v56
  v_add_f32 v133, v133, v57
  v_add_f32 v134, v134, v58
  v_add_f32 v135, v135, v59
  v_add_f32 v132, s71, v132
  v_add_f32 v133, s71, v133
  v_add_f32 v134, s71, v134
  v_add_f32 v135, s71, v135
  v_mul_f32 v56, s70, v136
  v_mul_f32 v57, s70, v137
  v_mul_f32 v58, s70, v138
  v_mul_f32 v59, s70, v139
  v_exp_f32_e64 v56, v56 clamp
  v_exp_f32_e64 v57, v57 clamp
  v_exp_f32_e64 v58, v58 clamp
  v_exp_f32_e64 v59, v59 clamp
  v_max_f32 v136, 0, v136
  v_max_f32 v137, 0, v137
  v_max_f32 v138, 0, v138
  v_max_f32 v139, 0, v139
  v_add_f32 v136, v136, v56
  v_add_f32 v137, v137, v57
  v_add_f32 v138, v138, v58
  v_add_f32 v139, v139, v59
  v_add_f32 v136, s71, v136
  v_add_f32 v137, s71, v137
  v_add_f32 v138, s71, v138
  v_add_f32 v139, s71, v139
  v_mul_f32 v56, s70, v140
  v_mul_f32 v57, s70, v141
  v_mul_f32 v58, s70, v142
  v_mul_f32 v59, s70, v143
  v_exp_f32_e64 v56, v56 clamp
  v_exp_f32_e64 v57, v57 clamp
  v_exp_f32_e64 v58, v58 clamp
  v_exp_f32_e64 v59, v59 clamp
  v_max_f32 v140, 0, v140
  v_max_f32 v141, 0, v141
  v_max_f32 v142, 0, v142
  v_max_f32 v143, 0, v143
  v_add_f32 v140, v140, v56
  v_add_f32 v141, v141, v57
  v_add_f32 v142, v142, v58
  v_add_f32 v143, v143, v59
  v_add_f32 v140, s71, v140
  v_add_f32 v141, s71, v141
  v_add_f32 v142, s71, v142
  v_add_f32 v143, s71, v143
  v_cvt_pk_bf16_f32 v184, v128, v129
  v_cvt_pk_bf16_f32 v185, v130, v131
  v_cvt_pk_bf16_f32 v186, v132, v133
  v_cvt_pk_bf16_f32 v187, v134, v135
  v_cvt_pk_bf16_f32 v188, v136, v137
  v_cvt_pk_bf16_f32 v189, v138, v139
  v_cvt_pk_bf16_f32 v190, v140, v141
  v_cvt_pk_bf16_f32 v191, v142, v143
  v_mul_f32 v56, s70, v144
  v_mul_f32 v57, s70, v145
  v_mul_f32 v58, s70, v146
  v_mul_f32 v59, s70, v147
  v_exp_f32_e64 v56, v56 clamp
  v_exp_f32_e64 v57, v57 clamp
  v_exp_f32_e64 v58, v58 clamp
  v_exp_f32_e64 v59, v59 clamp
  v_max_f32 v144, 0, v144
  v_max_f32 v145, 0, v145
  v_max_f32 v146, 0, v146
  v_max_f32 v147, 0, v147
  v_add_f32 v144, v144, v56
  v_add_f32 v145, v145, v57
  v_add_f32 v146, v146, v58
  v_add_f32 v147, v147, v59
  v_add_f32 v144, s71, v144
  v_add_f32 v145, s71, v145
  v_add_f32 v146, s71, v146
  v_add_f32 v147, s71, v147
  v_mul_f32 v56, s70, v148
  v_mul_f32 v57, s70, v149
  v_mul_f32 v58, s70, v150
  v_mul_f32 v59, s70, v151
  v_exp_f32_e64 v56, v56 clamp
  v_exp_f32_e64 v57, v57 clamp
  v_exp_f32_e64 v58, v58 clamp
  v_exp_f32_e64 v59, v59 clamp
  v_max_f32 v148, 0, v148
  v_max_f32 v149, 0, v149
  v_max_f32 v150, 0, v150
  v_max_f32 v151, 0, v151
  v_add_f32 v148, v148, v56
  v_add_f32 v149, v149, v57
  v_add_f32 v150, v150, v58
  v_add_f32 v151, v151, v59
  v_add_f32 v148, s71, v148
  v_add_f32 v149, s71, v149
  v_add_f32 v150, s71, v150
  v_add_f32 v151, s71, v151
  v_mul_f32 v56, s70, v152
  v_mul_f32 v57, s70, v153
  v_mul_f32 v58, s70, v154
  v_mul_f32 v59, s70, v155
  v_exp_f32_e64 v56, v56 clamp
  v_exp_f32_e64 v57, v57 clamp
  v_exp_f32_e64 v58, v58 clamp
  v_exp_f32_e64 v59, v59 clamp
  v_max_f32 v152, 0, v152
  v_max_f32 v153, 0, v153
  v_max_f32 v154, 0, v154
  v_max_f32 v155, 0, v155
  v_add_f32 v152, v152, v56
  v_add_f32 v153, v153, v57
  v_add_f32 v154, v154, v58
  v_add_f32 v155, v155, v59
  v_add_f32 v152, s71, v152
  v_add_f32 v153, s71, v153
  v_add_f32 v154, s71, v154
  v_add_f32 v155, s71, v155
  v_mul_f32 v56, s70, v156
  v_mul_f32 v57, s70, v157
  v_mul_f32 v58, s70, v158
  v_mul_f32 v59, s70, v159
  v_exp_f32_e64 v56, v56 clamp
  v_exp_f32_e64 v57, v57 clamp
  v_exp_f32_e64 v58, v58 clamp
  v_exp_f32_e64 v59, v59 clamp
  v_max_f32 v156, 0, v156
  v_max_f32 v157, 0, v157
  v_max_f32 v158, 0, v158
  v_max_f32 v159, 0, v159
  v_add_f32 v156, v156, v56
  v_add_f32 v157, v157, v57
  v_add_f32 v158, v158, v58
  v_add_f32 v159, v159, v59
  v_add_f32 v156, s71, v156
  v_add_f32 v157, s71, v157
  v_add_f32 v158, s71, v158
  v_add_f32 v159, s71, v159
  v_cvt_pk_bf16_f32 v192, v144, v145
  v_cvt_pk_bf16_f32 v193, v146, v147
  v_cvt_pk_bf16_f32 v194, v148, v149
  v_cvt_pk_bf16_f32 v195, v150, v151
  v_cvt_pk_bf16_f32 v196, v152, v153
  v_cvt_pk_bf16_f32 v197, v154, v155
  v_cvt_pk_bf16_f32 v198, v156, v157
  v_cvt_pk_bf16_f32 v199, v158, v159
  s_mov_b32 s83, s63
  s_mov_b32 s84, s66
  s_mov_b32 s91, s64
  s_cmp_eq_u32 s76, 0
  s_cbranch_scc1 L_stage2_cons
  v_min_u32 v249, 15, v1
  v_lshlrev_b32 v249, 2, v249
  buffer_load_dword v248, v249, s[44:47], s84 offen sc1
  s_waitcnt vmcnt(0)
  v_cmp_ne_u32 vcc, s74, v248
  s_cbranch_vccz Lkok_30
  s_mov_b32 s95, 0x8000
Lpoll_31:
  buffer_load_dword v248, v249, s[44:47], s84 offen sc1
  s_waitcnt vmcnt(0)
  v_cmp_ne_u32 vcc, s74, v248
  s_cbranch_vccz Lpdone_32
  s_sleep 1
  s_sub_u32 s95, s95, 1
  s_cmp_lg_u32 s95, 0
  s_cbranch_scc1 Lpoll_31
Lpdone_32:
Lkok_30:
  v_lshlrev_b32 v249, 2, v1
  s_add_u32 s35, s83, 0
  buffer_load_dword v168, v249, s[44:47], s35 offen offset:0 sc1
  buffer_load_dword v169, v249, s[44:47], s35 offen offset:256 sc1
  buffer_load_dword v170, v249, s[44:47], s35 offen offset:512 sc1
  buffer_load_dword v171, v249, s[44:47], s35 offen offset:768 sc1
  buffer_load_dword v172, v249, s[44:47], s35 offen offset:1024 sc1
  buffer_load_dword v173, v249, s[44:47], s35 offen offset:1280 sc1
  buffer_load_dword v174, v249, s[44:47], s35 offen offset:1536 sc1
  buffer_load_dword v175, v249, s[44:47], s35 offen offset:1792 sc1
  buffer_load_dword v176, v249, s[44:47], s35 offen offset:2048 sc1
  buffer_load_dword v177, v249, s[44:47], s35 offen offset:2304 sc1
  buffer_load_dword v178, v249, s[44:47], s35 offen offset:2560 sc1
  buffer_load_dword v179, v249, s[44:47], s35 offen offset:2816 sc1
  buffer_load_dword v180, v249, s[44:47], s35 offen offset:3072 sc1
  buffer_load_dword v181, v249, s[44:47], s35 offen offset:3328 sc1
  buffer_load_dword v182, v249, s[44:47], s35 offen offset:3584 sc1
  buffer_load_dword v183, v249, s[44:47], s35 offen offset:3840 sc1
  s_add_u32 s35, s83, 4096
  buffer_load_dword v200, v249, s[44:47], s35 offen offset:0 sc1
  buffer_load_dword v201, v249, s[44:47], s35 offen offset:256 sc1
  buffer_load_dword v202, v249, s[44:47], s35 offen offset:512 sc1
  buffer_load_dword v203, v249, s[44:47], s35 offen offset:768 sc1
  buffer_load_dword v204, v249, s[44:47], s35 offen offset:1024 sc1
  buffer_load_dword v205, v249, s[44:47], s35 offen offset:1280 sc1
  buffer_load_dword v206, v249, s[44:47], s35 offen offset:1536 sc1
  buffer_load_dword v207, v249, s[44:47], s35 offen offset:1792 sc1
  buffer_load_dword v208, v249, s[44:47], s35 offen offset:2048 sc1
  buffer_load_dword v209, v249, s[44:47], s35 offen offset:2304 sc1
  buffer_load_dword v210, v249, s[44:47], s35 offen offset:2560 sc1
  buffer_load_dword v211, v249, s[44:47], s35 offen offset:2816 sc1
  buffer_load_dword v212, v249, s[44:47], s35 offen offset:3072 sc1
  buffer_load_dword v213, v249, s[44:47], s35 offen offset:3328 sc1
  buffer_load_dword v214, v249, s[44:47], s35 offen offset:3584 sc1
  buffer_load_dword v215, v249, s[44:47], s35 offen offset:3840 sc1
  s_waitcnt vmcnt(0)
  s_mov_b32 s71, 897988541
  v_cmp_eq_u32 vcc, 0, v3
  s_nop 1
  v_cndmask_b32 v180, 0, v180, vcc
  v_cndmask_b32 v181, 0, v181, vcc
  v_cndmask_b32 v182, 0, v182, vcc
  v_cndmask_b32 v183, 0, v183, vcc
  v_cvt_pk_bf16_f32 v216, v168, v169
  v_cvt_pk_bf16_f32 v217, v170, v171
  v_cvt_pk_bf16_f32 v218, v172, v173
  v_cvt_pk_bf16_f32 v219, v174, v175
  v_cvt_pk_bf16_f32 v220, v176, v177
  v_cvt_pk_bf16_f32 v221, v178, v179
  v_cvt_pk_bf16_f32 v222, v180, v181
  v_cvt_pk_bf16_f32 v223, v182, v183
  v_cndmask_b32 v212, 0, v212, vcc
  v_cndmask_b32 v213, 0, v213, vcc
  v_cndmask_b32 v214, 0, v214, vcc
  v_cndmask_b32 v215, 0, v215, vcc
  v_cvt_pk_bf16_f32 v232, v200, v201
  v_cvt_pk_bf16_f32 v233, v202, v203
  v_cvt_pk_bf16_f32 v234, v204, v205
  v_cvt_pk_bf16_f32 v235, v206, v207
  v_cvt_pk_bf16_f32 v236, v208, v209
  v_cvt_pk_bf16_f32 v237, v210, v211
  v_cvt_pk_bf16_f32 v238, v212, v213
  v_cvt_pk_bf16_f32 v239, v214, v215
  v_mfma_f32_32x32x16_bf16 v[168:183], v[216:219], v[184:187], 0
  v_mfma_f32_32x32x16_bf16 v[168:183], v[220:223], v[188:191], v[168:183]
  v_mfma_f32_32x32x16_bf16 v[200:215], v[232:235], v[192:195], 0
  v_mfma_f32_32x32x16_bf16 v[200:215], v[236:239], v[196:199], v[200:215]
  v_lshlrev_b32 v248, 4, v2
  v_lshl_add_u32 v249, v3, 10, v248
  s_nop 7
  v_mov_b32 v7, v180
  v_mov_b32 v8, v180
  s_nop 1
  v_permlane32_swap_b32 v7, v8
  v_add_f32 v8, s71, v8
  v_rcp_f32 v8, v8
  s_nop 0
  v_mul_f32 v168, v168, v8
  v_mul_f32 v169, v169, v8
  v_mul_f32 v170, v170, v8
  v_mul_f32 v171, v171, v8
  v_mul_f32 v172, v172, v8
  v_mul_f32 v173, v173, v8
  v_mul_f32 v174, v174, v8
  v_mul_f32 v175, v175, v8
  v_mul_f32 v176, v176, v8
  v_mul_f32 v177, v177, v8
  v_mul_f32 v178, v178, v8
  v_mul_f32 v179, v179, v8
  v_mul_f32 v180, v180, v8
  v_mul_f32 v181, v181, v8
  v_mul_f32 v182, v182, v8
  v_mul_f32 v183, v183, v8
  v_cndmask_b32 v180, 0, v180, vcc
  v_cndmask_b32 v181, 0, v181, vcc
  v_cndmask_b32 v182, 0, v182, vcc
  v_cndmask_b32 v183, 0, v183, vcc
  s_add_u32 s35, s91, 0
  v_cvt_pk_bf16_f32 v240, v168, v169
  v_cvt_pk_bf16_f32 v241, v170, v171
  v_cvt_pk_bf16_f32 v242, v172, v173
  v_cvt_pk_bf16_f32 v243, v174, v175
  buffer_store_dwordx4 v[240:243], v249, s[44:47], s35 offen offset:0 sc1
  v_cvt_pk_bf16_f32 v244, v176, v177
  v_cvt_pk_bf16_f32 v245, v178, v179
  v_cvt_pk_bf16_f32 v246, v180, v181
  v_cvt_pk_bf16_f32 v247, v182, v183
  buffer_store_dwordx4 v[244:247], v249, s[44:47], s35 offen offset:2048 sc1
  v_mov_b32 v7, v212
  v_mov_b32 v8, v212
  s_nop 1
  v_permlane32_swap_b32 v7, v8
  v_add_f32 v8, s71, v8
  v_rcp_f32 v8, v8
  s_nop 0
  v_mul_f32 v200, v200, v8
  v_mul_f32 v201, v201, v8
  v_mul_f32 v202, v202, v8
  v_mul_f32 v203, v203, v8
  v_mul_f32 v204, v204, v8
  v_mul_f32 v205, v205, v8
  v_mul_f32 v206, v206, v8
  v_mul_f32 v207, v207, v8
  v_mul_f32 v208, v208, v8
  v_mul_f32 v209, v209, v8
  v_mul_f32 v210, v210, v8
  v_mul_f32 v211, v211, v8
  v_mul_f32 v212, v212, v8
  v_mul_f32 v213, v213, v8
  v_mul_f32 v214, v214, v8
  v_mul_f32 v215, v215, v8
  v_cndmask_b32 v212, 0, v212, vcc
  v_cndmask_b32 v213, 0, v213, vcc
  v_cndmask_b32 v214, 0, v214, vcc
  v_cndmask_b32 v215, 0, v215, vcc
  s_add_u32 s35, s91, 4096
  v_cvt_pk_bf16_f32 v240, v200, v201
  v_cvt_pk_bf16_f32 v241, v202, v203
  v_cvt_pk_bf16_f32 v242, v204, v205
  v_cvt_pk_bf16_f32 v243, v206, v207
  buffer_store_dwordx4 v[240:243], v249, s[44:47], s35 offen offset:0 sc1
  v_cvt_pk_bf16_f32 v244, v208, v209
  v_cvt_pk_bf16_f32 v245, v210, v211
  v_cvt_pk_bf16_f32 v246, v212, v213
  v_cvt_pk_bf16_f32 v247, v214, v215
  buffer_store_dwordx4 v[244:247], v249, s[44:47], s35 offen offset:2048 sc1
  s_waitcnt vmcnt(0)
  s_barrier
  s_cmp_lg_u32 s28, 0
  s_cbranch_scc1 Lpub_33
  v_mov_b32 v7, s74
  v_mov_b32 v8, 0
  s_mov_b64 exec, 1
  buffer_store_dword v7, v8, s[44:47], s82 offen sc1
  s_mov_b64 exec, -1
Lpub_33:
  s_barrier
  v_subrev_u32 v10, 65536, v10
  v_subrev_u32 v11, 65536, v11
  v_subrev_u32 v12, 65536, v12
  v_subrev_u32 v13, 65536, v13
  ds_read_b128 v[24:27], v10 offset:0
  ds_read_b128 v[28:31], v20 offset:32768
  ds_read_b128 v[32:35], v11 offset:0
  ds_read_b128 v[36:39], v20 offset:32800
  ds_read_b128 v[40:43], v12 offset:0
  ds_read_b128 v[44:47], v20 offset:32832
  ds_read_b128 v[48:51], v13 offset:0
  ds_read_b128 v[52:55], v20 offset:32864
  s_waitcnt lgkmcnt(6)
  v_mfma_f32_32x32x16_bf16 v[160:175], v[28:31], v[24:27], 0
  s_waitcnt lgkmcnt(0)
  s_barrier
  ds_read_b128 v[56:59], v10 offset:16384
  ds_read_b128 v[60:63], v20 offset:0
  ds_read_b128 v[64:67], v11 offset:16384
  v_mfma_f32_32x32x16_bf16 v[160:175], v[36:39], v[32:35], v[160:175]
  ds_read_b128 v[68:71], v20 offset:32
  ds_read_b128 v[72:75], v12 offset:16384
  ds_read_b128 v[76:79], v20 offset:64
  v_mfma_f32_32x32x16_bf16 v[160:175], v[44:47], v[40:43], v[160:175]
  ds_read_b128 v[80:83], v13 offset:16384
  ds_read_b128 v[84:87], v20 offset:96
  v_mfma_f32_32x32x16_bf16 v[160:175], v[52:55], v[48:51], v[160:175]
  s_waitcnt lgkmcnt(6)
  v_mfma_f32_32x32x16_bf16 v[160:175], v[60:63], v[56:59], v[160:175]
  s_waitcnt lgkmcnt(0)
  s_barrier
  ds_read_b128 v[24:27], v10 offset:32768
  ds_read_b128 v[28:31], v20 offset:16384
  ds_read_b128 v[32:35], v11 offset:32768
  v_mfma_f32_32x32x16_bf16 v[160:175], v[68:71], v[64:67], v[160:175]
  ds_read_b128 v[36:39], v20 offset:16416
  ds_read_b128 v[40:43], v12 offset:32768
  ds_read_b128 v[44:47], v20 offset:16448
  v_mfma_f32_32x32x16_bf16 v[160:175], v[76:79], v[72:75], v[160:175]
  ds_read_b128 v[48:51], v13 offset:32768
  ds_read_b128 v[52:55], v20 offset:16480
  v_mfma_f32_32x32x16_bf16 v[160:175], v[84:87], v[80:83], v[160:175]
  s_waitcnt lgkmcnt(6)
  v_mfma_f32_32x32x16_bf16 v[160:175], v[28:31], v[24:27], v[160:175]
  s_waitcnt lgkmcnt(0)
  s_barrier
  ds_read_b128 v[56:59], v10 offset:49152
  ds_read_b128 v[60:63], v20 offset:32768
  ds_read_b128 v[64:67], v11 offset:49152
  v_mfma_f32_32x32x16_bf16 v[160:175], v[36:39], v[32:35], v[160:175]
  ds_read_b128 v[68:71], v20 offset:32800
  ds_read_b128 v[72:75], v12 offset:49152
  ds_read_b128 v[76:79], v20 offset:32832
  v_mfma_f32_32x32x16_bf16 v[160:175], v[44:47], v[40:43], v[160:175]
  ds_read_b128 v[80:83], v13 offset:49152
  ds_read_b128 v[84:87], v20 offset:32864
  v_mfma_f32_32x32x16_bf16 v[160:175], v[52:55], v[48:51], v[160:175]
  s_waitcnt lgkmcnt(6)
  v_mfma_f32_32x32x16_bf16 v[160:175], v[60:63], v[56:59], v[160:175]
  s_waitcnt lgkmcnt(0)
  s_barrier
  v_add_u32 v10, 65536, v10
  v_add_u32 v11, 65536, v11
  v_add_u32 v12, 65536, v12
  v_add_u32 v13, 65536, v13
  ds_read_b128 v[24:27], v10 offset:0
  ds_read_b128 v[28:31], v20 offset:0
  ds_read_b128 v[32:35], v11 offset:0
  v_mfma_f32_32x32x16_bf16 v[160:175], v[68:71], v[64:67], v[160:175]
  ds_read_b128 v[36:39], v20 offset:32
  ds_read_b128 v[40:43], v12 offset:0
  ds_read_b128 v[44:47], v20 offset:64
  v_mfma_f32_32x32x16_bf16 v[160:175], v[76:79], v[72:75], v[160:175]
  ds_read_b128 v[48:51], v13 offset:0
  ds_read_b128 v[52:55], v20 offset:96
  v_mfma_f32_32x32x16_bf16 v[160:175], v[84:87], v[80:83], v[160:175]
  s_waitcnt lgkmcnt(6)
  v_mfma_f32_32x32x16_bf16 v[160:175], v[28:31], v[24:27], v[160:175]
  s_waitcnt lgkmcnt(0)
  s_barrier
  ds_read_b128 v[56:59], v10 offset:16384
  ds_read_b128 v[60:63], v20 offset:16384
  ds_read_b128 v[64:67], v11 offset:16384
  v_mfma_f32_32x32x16_bf16 v[160:175], v[36:39], v[32:35], v[160:175]
  ds_read_b128 v[68:71], v20 offset:16416
  ds_read_b128 v[72:75], v12 offset:16384
  ds_read_b128 v[76:79], v20 offset:16448
  v_mfma_f32_32x32x16_bf16 v[160:175], v[44:47], v[40:43], v[160:175]
  ds_read_b128 v[80:83], v13 offset:16384
  ds_read_b128 v[84:87], v20 offset:16480
  v_mfma_f32_32x32x16_bf16 v[160:175], v[52:55], v[48:51], v[160:175]
  s_waitcnt lgkmcnt(6)
  v_mfma_f32_32x32x16_bf16 v[160:175], v[60:63], v[56:59], v[160:175]
  s_waitcnt lgkmcnt(0)
  s_barrier
  ds_read_b128 v[24:27], v10 offset:32768
  ds_read_b128 v[28:31], v20 offset:32768
  ds_read_b128 v[32:35], v11 offset:32768
  v_mfma_f32_32x32x16_bf16 v[160:175], v[68:71], v[64:67], v[160:175]
  ds_read_b128 v[36:39], v20 offset:32800
  ds_read_b128 v[40:43], v12 offset:32768
  ds_read_b128 v[44:47], v20 offset:32832
  v_mfma_f32_32x32x16_bf16 v[160:175], v[76:79], v[72:75], v[160:175]
  ds_read_b128 v[48:51], v13 offset:32768
  ds_read_b128 v[52:55], v20 offset:32864
  v_mfma_f32_32x32x16_bf16 v[160:175], v[84:87], v[80:83], v[160:175]
  s_waitcnt lgkmcnt(6)
  v_mfma_f32_32x32x16_bf16 v[160:175], v[28:31], v[24:27], v[160:175]
  s_waitcnt lgkmcnt(0)
  s_barrier
  v_mfma_f32_32x32x16_bf16 v[160:175], v[36:39], v[32:35], v[160:175]
  v_mfma_f32_32x32x16_bf16 v[160:175], v[44:47], v[40:43], v[160:175]
  v_mfma_f32_32x32x16_bf16 v[160:175], v[52:55], v[48:51], v[160:175]
  s_nop 7
  s_nop 3
  v_mul_f32 v7, s70, v160
  v_exp_f32_e64 v7, -v7
  s_nop 0
  v_add_f32 v7, 1.0, v7
  v_rcp_f32 v7, v7
  v_lshlrev_b32 v8, 2, v2
  v_lshl_add_u32 v8, v3, 30, v8
  s_lshl_b32 s35, s30, 2
  s_add_u32 s35, s35, s29
  s_lshl_b32 s35, s35, 7
  s_add_u32 s35, s35, 16384
  buffer_store_dword v7, v8, s[44:47], s35 offen sc1
  s_waitcnt vmcnt(0)
  s_barrier
  s_lshl_b32 s81, s30, 7
  s_add_u32 s81, s81, 11296
  s_cmp_lg_u32 s28, 0
  s_cbranch_scc1 Lpub_34
  v_mov_b32 v7, s74
  v_mov_b32 v8, 0
  s_mov_b64 exec, 1
  buffer_store_dword v7, v8, s[44:47], s81 offen sc1
  s_mov_b64 exec, -1
Lpub_34:
  s_or_b32 s35, s30, s28
  s_cmp_lg_u32 s35, 0
  s_cbranch_scc1 L_end
  v_lshrrev_b32 v7, 3, v1
  v_lshlrev_b32 v7, 7, v7
  v_and_b32 v8, 7, v1
  v_lshl_add_u32 v7, v8, 2, v7
  s_mov_b32 s81, 2048
  s_mov_b32 s95, 0x8000
Lpoll_35:
  buffer_load_dword v9, v7, s[44:47], s81 offen sc1
  s_waitcnt vmcnt(0)
  v_cmp_ne_u32 vcc, s74, v9
  s_cbranch_vccz Lpdone_36
  s_sleep 1
  s_sub_u32 s95, s95, 1
  s_cmp_lg_u32 s95, 0
  s_cbranch_scc1 Lpoll_35
Lpdone_36:
  s_mov_b32 s81, 3072
  s_mov_b32 s95, 0x8000
Lpoll_37:
  buffer_load_dword v9, v7, s[44:47], s81 offen sc1
  s_waitcnt vmcnt(0)
  v_cmp_ne_u32 vcc, s74, v9
  s_cbranch_vccz Lpdone_38
  s_sleep 1
  s_sub_u32 s95, s95, 1
  s_cmp_lg_u32 s95, 0
  s_cbranch_scc1 Lpoll_37
Lpdone_38:
  v_lshrrev_b32 v7, 4, v1
  v_lshlrev_b32 v7, 7, v7
  v_and_b32 v8, 15, v1
  v_lshl_add_u32 v7, v8, 2, v7
  s_mov_b32 s81, 4096
  s_mov_b32 s95, 0x8000
Lpoll_39:
  buffer_load_dword v9, v7, s[44:47], s81 offen sc1
  s_waitcnt vmcnt(0)
  v_cmp_ne_u32 vcc, s74, v9
  s_cbranch_vccz Lpdone_40
  s_sleep 1
  s_sub_u32 s95, s95, 1
  s_cmp_lg_u32 s95, 0
  s_cbranch_scc1 Lpoll_39
Lpdone_40:
  s_mov_b32 s81, 4608
  s_mov_b32 s95, 0x8000
Lpoll_41:
  buffer_load_dword v9, v7, s[44:47], s81 offen sc1
  s_waitcnt vmcnt(0)
  v_cmp_ne_u32 vcc, s74, v9
  s_cbranch_vccz Lpdone_42
  s_sleep 1
  s_sub_u32 s95, s95, 1
  s_cmp_lg_u32 s95, 0
  s_cbranch_scc1 Lpoll_41
Lpdone_42:
  s_mov_b32 s81, 8192
  s_cmp_lg_u32 s28, 0
  s_cbranch_scc1 Lpub_43
  v_mov_b32 v7, s74
  v_mov_b32 v8, 0
  s_mov_b64 exec, 1
  buffer_store_dword v7, v8, s[44:47], s81 offen sc1
  s_mov_b64 exec, -1
Lpub_43:
  s_endpgm
L_stage2_cons:
  s_mov_b32 s56, s22
  s_and_b32 s57, s23, 0xffff
  s_mov_b32 s58, 1835008
  s_mov_b32 s59, 0x20000
  s_lshr_b32 s60, s29, 1
  s_and_b32 s61, s29, 1
  s_lshl_b32 s35, s60, 12
  v_lshlrev_b32 v7, 4, v2
  v_lshl_add_u32 v7, v3, 10, v7
  v_add_u32 v10, s35, v7
  v_lshl_add_u32 v7, v3, 2, v5
  s_lshl_b32 s35, s60, 5
  v_add_u32 v7, s35, v7
  v_lshlrev_b32 v7, 7, v7
  v_lshrrev_b32 v8, 1, v5
  v_xor_b32 v8, s61, v8
  v_lshl_add_u32 v7, v8, 6, v7
  v_lshl_add_u32 v7, v4, 5, v7
  v_lshl_add_u32 v7, v6, 3, v7
  v_add_u32 v13, 8192, v7
  v_add_u32 v11, 65536, v10
  v_add_u32 v14, 65536, v13
  v_add_u32 v12, 131072, v10
  v_add_u32 v15, 131072, v13
  v_lshlrev_b32 v19, 2, v2
  v_lshlrev_b32 v18, 4, v1
  s_lshl_b32 s35, s61, 5
  v_lshlrev_b32 v7, 2, v3
  v_add_u32 v7, s35, v7
  ds_bpermute_b32 v24, v7, v224 offset:0
  ds_bpermute_b32 v25, v7, v225 offset:0
  ds_bpermute_b32 v26, v7, v224 offset:8
  ds_bpermute_b32 v27, v7, v225 offset:8
  ds_bpermute_b32 v28, v7, v224 offset:16
  ds_bpermute_b32 v29, v7, v225 offset:16
  ds_bpermute_b32 v30, v7, v224 offset:24
  ds_bpermute_b32 v31, v7, v225 offset:24
  s_waitcnt lgkmcnt(0)
  v_lshlrev_b32 v72, 16, v24
  v_and_b32 v73, 0xffff0000, v24
  v_lshlrev_b32 v74, 16, v25
  v_and_b32 v75, 0xffff0000, v25
  v_lshlrev_b32 v88, 16, v24
  v_and_b32 v89, 0xffff0000, v24
  v_lshlrev_b32 v90, 16, v25
  v_and_b32 v91, 0xffff0000, v25
  v_lshlrev_b32 v76, 16, v26
  v_and_b32 v77, 0xffff0000, v26
  v_lshlrev_b32 v78, 16, v27
  v_and_b32 v79, 0xffff0000, v27
  v_lshlrev_b32 v92, 16, v26
  v_and_b32 v93, 0xffff0000, v26
  v_lshlrev_b32 v94, 16, v27
  v_and_b32 v95, 0xffff0000, v27
  v_lshlrev_b32 v80, 16, v28
  v_and_b32 v81, 0xffff0000, v28
  v_lshlrev_b32 v82, 16, v29
  v_and_b32 v83, 0xffff0000, v29
  v_lshlrev_b32 v96, 16, v28
  v_and_b32 v97, 0xffff0000, v28
  v_lshlrev_b32 v98, 16, v29
  v_and_b32 v99, 0xffff0000, v29
  v_lshlrev_b32 v84, 16, v30
  v_and_b32 v85, 0xffff0000, v30
  v_lshlrev_b32 v86, 16, v31
  v_and_b32 v87, 0xffff0000, v31
  v_lshlrev_b32 v100, 16, v30
  v_and_b32 v101, 0xffff0000, v30
  v_lshlrev_b32 v102, 16, v31
  v_and_b32 v103, 0xffff0000, v31
  s_cmp_eq_u32 s60, 0
  s_cbranch_scc1 Lz_44
  v_mov_b32 v72, 0
  v_mov_b32 v73, 0
  v_mov_b32 v74, 0
  v_mov_b32 v75, 0
  v_mov_b32 v76, 0
  v_mov_b32 v77, 0
  v_mov_b32 v78, 0
  v_mov_b32 v79, 0
  v_mov_b32 v80, 0
  v_mov_b32 v81, 0
  v_mov_b32 v82, 0
  v_mov_b32 v83, 0
  v_mov_b32 v84, 0
  v_mov_b32 v85, 0
  v_mov_b32 v86, 0
  v_mov_b32 v87, 0
  v_mov_b32 v88, 0
  v_mov_b32 v89, 0
  v_mov_b32 v90, 0
  v_mov_b32 v91, 0
  v_mov_b32 v92, 0
  v_mov_b32 v93, 0
  v_mov_b32 v94, 0
  v_mov_b32 v95, 0
  v_mov_b32 v96, 0
  v_mov_b32 v97, 0
  v_mov_b32 v98, 0
  v_mov_b32 v99, 0
  v_mov_b32 v100, 0
  v_mov_b32 v101, 0
  v_mov_b32 v102, 0
  v_mov_b32 v103, 0
Lz_44:
  s_nop 0
  s_cmp_eq_u32 s75, 0
  s_cbranch_scc1 Lgp_45
  s_waitcnt vmcnt(0)
Lgp_45:
  s_barrier
  s_cmp_eq_u32 s75, 0
  s_cbranch_scc1 Lgq_46
  s_cmp_lg_u32 s28, 0
  s_cbranch_scc1 Lpub_47
  v_mov_b32 v7, s74
  v_mov_b32 v8, 0
  s_mov_b64 exec, 1
  buffer_store_dword v7, v8, s[44:47], s82 offen sc1
  s_mov_b64 exec, -1
Lpub_47:
Lgq_46:
  s_barrier
  ds_read_b64_tr_b16 v[24:25], v13 offset:0
  ds_read_b64_tr_b16 v[26:27], v13 offset:1024
  ds_read_b128 v[28:31], v10 offset:0
  ds_read_b128 v[32:35], v10 offset:512
  ds_read_b64_tr_b16 v[36:37], v13 offset:2048
  ds_read_b64_tr_b16 v[38:39], v13 offset:3072
  ds_read_b128 v[40:43], v10 offset:2048
  ds_read_b128 v[44:47], v10 offset:2560
  s_waitcnt lgkmcnt(0)
  s_barrier
  v_mfma_f32_32x32x16_bf16 v[72:87], v[24:27], v[28:31], v[72:87]
  ds_read_b64_tr_b16 v[48:49], v13 offset:16384
  ds_read_b64_tr_b16 v[50:51], v13 offset:17408
  ds_read_b128 v[52:55], v10 offset:16384
  v_mfma_f32_32x32x16_bf16 v[88:103], v[24:27], v[32:35], v[88:103]
  ds_read_b128 v[56:59], v10 offset:16896
  ds_read_b64_tr_b16 v[60:61], v13 offset:18432
  ds_read_b64_tr_b16 v[62:63], v13 offset:19456
  v_mfma_f32_32x32x16_bf16 v[72:87], v[36:39], v[40:43], v[72:87]
  ds_read_b128 v[64:67], v10 offset:18432
  ds_read_b128 v[68:71], v10 offset:18944
  v_mfma_f32_32x32x16_bf16 v[88:103], v[36:39], v[44:47], v[88:103]
  s_waitcnt lgkmcnt(0)
  s_barrier
  v_mfma_f32_32x32x16_bf16 v[72:87], v[48:51], v[52:55], v[72:87]
  ds_read_b64_tr_b16 v[24:25], v13 offset:32768
  ds_read_b64_tr_b16 v[26:27], v13 offset:33792
  ds_read_b128 v[28:31], v10 offset:32768
  v_mfma_f32_32x32x16_bf16 v[88:103], v[48:51], v[56:59], v[88:103]
  ds_read_b128 v[32:35], v10 offset:33280
  ds_read_b64_tr_b16 v[36:37], v13 offset:34816
  ds_read_b64_tr_b16 v[38:39], v13 offset:35840
  v_mfma_f32_32x32x16_bf16 v[72:87], v[60:63], v[64:67], v[72:87]
  ds_read_b128 v[40:43], v10 offset:34816
  ds_read_b128 v[44:47], v10 offset:35328
  v_mfma_f32_32x32x16_bf16 v[88:103], v[60:63], v[68:71], v[88:103]
  s_waitcnt lgkmcnt(0)
  s_barrier
  v_mfma_f32_32x32x16_bf16 v[72:87], v[24:27], v[28:31], v[72:87]
  ds_read_b64_tr_b16 v[48:49], v13 offset:49152
  ds_read_b64_tr_b16 v[50:51], v13 offset:50176
  ds_read_b128 v[52:55], v10 offset:49152
  v_mfma_f32_32x32x16_bf16 v[88:103], v[24:27], v[32:35], v[88:103]
  ds_read_b128 v[56:59], v10 offset:49664
  ds_read_b64_tr_b16 v[60:61], v13 offset:51200
  ds_read_b64_tr_b16 v[62:63], v13 offset:52224
  v_mfma_f32_32x32x16_bf16 v[72:87], v[36:39], v[40:43], v[72:87]
  ds_read_b128 v[64:67], v10 offset:51200
  ds_read_b128 v[68:71], v10 offset:51712
  v_mfma_f32_32x32x16_bf16 v[88:103], v[36:39], v[44:47], v[88:103]
  s_waitcnt lgkmcnt(0)
  s_barrier
  v_mfma_f32_32x32x16_bf16 v[72:87], v[48:51], v[52:55], v[72:87]
  ds_read_b64_tr_b16 v[24:25], v14 offset:0
  ds_read_b64_tr_b16 v[26:27], v14 offset:1024
  ds_read_b128 v[28:31], v11 offset:0
  v_mfma_f32_32x32x16_bf16 v[88:103], v[48:51], v[56:59], v[88:103]
  ds_read_b128 v[32:35], v11 offset:512
  ds_read_b64_tr_b16 v[36:37], v14 offset:2048
  ds_read_b64_tr_b16 v[38:39], v14 offset:3072
  v_mfma_f32_32x32x16_bf16 v[72:87], v[60:63], v[64:67], v[72:87]
  ds_read_b128 v[40:43], v11 offset:2048
  ds_read_b128 v[44:47], v11 offset:2560
  v_mfma_f32_32x32x16_bf16 v[88:103], v[60:63], v[68:71], v[88:103]
  s_waitcnt lgkmcnt(0)
  s_barrier
  v_mfma_f32_32x32x16_bf16 v[72:87], v[24:27], v[28:31], v[72:87]
  ds_read_b64_tr_b16 v[48:49], v14 offset:16384
  ds_read_b64_tr_b16 v[50:51], v14 offset:17408
  ds_read_b128 v[52:55], v11 offset:16384
  v_mfma_f32_32x32x16_bf16 v[88:103], v[24:27], v[32:35], v[88:103]
  ds_read_b128 v[56:59], v11 offset:16896
  ds_read_b64_tr_b16 v[60:61], v14 offset:18432
  ds_read_b64_tr_b16 v[62:63], v14 offset:19456
  v_mfma_f32_32x32x16_bf16 v[72:87], v[36:39], v[40:43], v[72:87]
  ds_read_b128 v[64:67], v11 offset:18432
  ds_read_b128 v[68:71], v11 offset:18944
  v_mfma_f32_32x32x16_bf16 v[88:103], v[36:39], v[44:47], v[88:103]
  s_waitcnt lgkmcnt(0)
  s_barrier
  v_mfma_f32_32x32x16_bf16 v[72:87], v[48:51], v[52:55], v[72:87]
  ds_read_b64_tr_b16 v[24:25], v14 offset:32768
  ds_read_b64_tr_b16 v[26:27], v14 offset:33792
  ds_read_b128 v[28:31], v11 offset:32768
  v_mfma_f32_32x32x16_bf16 v[88:103], v[48:51], v[56:59], v[88:103]
  ds_read_b128 v[32:35], v11 offset:33280
  ds_read_b64_tr_b16 v[36:37], v14 offset:34816
  ds_read_b64_tr_b16 v[38:39], v14 offset:35840
  v_mfma_f32_32x32x16_bf16 v[72:87], v[60:63], v[64:67], v[72:87]
  ds_read_b128 v[40:43], v11 offset:34816
  ds_read_b128 v[44:47], v11 offset:35328
  v_mfma_f32_32x32x16_bf16 v[88:103], v[60:63], v[68:71], v[88:103]
  s_waitcnt lgkmcnt(0)
  s_barrier
  s_cmp_eq_u32 s75, 1
  s_cbranch_scc1 Loi_48
  v_lshlrev_b32 v249, 2, v1
  v_add_u32 v249, 147456, v249
  ds_read_b32 v168, v249 offset:0
  ds_read_b32 v169, v249 offset:256
  ds_read_b32 v170, v249 offset:512
  ds_read_b32 v171, v249 offset:768
  ds_read_b32 v172, v249 offset:1024
  ds_read_b32 v173, v249 offset:1280
  ds_read_b32 v174, v249 offset:1536
  ds_read_b32 v175, v249 offset:1792
  ds_read_b32 v176, v249 offset:2048
  ds_read_b32 v177, v249 offset:2304
  ds_read_b32 v178, v249 offset:2560
  ds_read_b32 v179, v249 offset:2816
  ds_read_b32 v180, v249 offset:3072
  ds_read_b32 v181, v249 offset:3328
  ds_read_b32 v182, v249 offset:3584
  ds_read_b32 v183, v249 offset:3840
  s_waitcnt lgkmcnt(0)
  ds_read_b32 v200, v249 offset:4096
  ds_read_b32 v201, v249 offset:4352
  ds_read_b32 v202, v249 offset:4608
  ds_read_b32 v203, v249 offset:4864
  ds_read_b32 v204, v249 offset:5120
  ds_read_b32 v205, v249 offset:5376
  ds_read_b32 v206, v249 offset:5632
  ds_read_b32 v207, v249 offset:5888
  ds_read_b32 v208, v249 offset:6144
  ds_read_b32 v209, v249 offset:6400
  ds_read_b32 v210, v249 offset:6656
  ds_read_b32 v211, v249 offset:6912
  ds_read_b32 v212, v249 offset:7168
  ds_read_b32 v213, v249 offset:7424
  ds_read_b32 v214, v249 offset:7680
  ds_read_b32 v215, v249 offset:7936
  s_waitcnt lgkmcnt(0)
  s_mov_b32 s71, 897988541
  v_cmp_eq_u32 vcc, 0, v3
  s_nop 1
  v_cndmask_b32 v180, 0, v180, vcc
  v_cndmask_b32 v181, 0, v181, vcc
  v_cndmask_b32 v182, 0, v182, vcc
  v_cndmask_b32 v183, 0, v183, vcc
  v_cvt_pk_bf16_f32 v216, v168, v169
  v_cvt_pk_bf16_f32 v217, v170, v171
  v_cvt_pk_bf16_f32 v218, v172, v173
  v_cvt_pk_bf16_f32 v219, v174, v175
  v_cvt_pk_bf16_f32 v220, v176, v177
  v_cvt_pk_bf16_f32 v221, v178, v179
  v_cvt_pk_bf16_f32 v222, v180, v181
  v_cvt_pk_bf16_f32 v223, v182, v183
  v_cndmask_b32 v212, 0, v212, vcc
  v_cndmask_b32 v213, 0, v213, vcc
  v_cndmask_b32 v214, 0, v214, vcc
  v_cndmask_b32 v215, 0, v215, vcc
  v_cvt_pk_bf16_f32 v232, v200, v201
  v_cvt_pk_bf16_f32 v233, v202, v203
  v_cvt_pk_bf16_f32 v234, v204, v205
  v_cvt_pk_bf16_f32 v235, v206, v207
  v_cvt_pk_bf16_f32 v236, v208, v209
  v_cvt_pk_bf16_f32 v237, v210, v211
  v_cvt_pk_bf16_f32 v238, v212, v213
  v_cvt_pk_bf16_f32 v239, v214, v215
  v_mfma_f32_32x32x16_bf16 v[168:183], v[216:219], v[184:187], 0
  v_mfma_f32_32x32x16_bf16 v[168:183], v[220:223], v[188:191], v[168:183]
  v_mfma_f32_32x32x16_bf16 v[200:215], v[232:235], v[192:195], 0
  v_mfma_f32_32x32x16_bf16 v[200:215], v[236:239], v[196:199], v[200:215]
  v_lshlrev_b32 v248, 4, v2
  v_lshl_add_u32 v249, v3, 10, v248
  s_nop 7
  v_mov_b32 v7, v180
  v_mov_b32 v8, v180
  s_nop 1
  v_permlane32_swap_b32 v7, v8
  v_add_f32 v8, s71, v8
  v_rcp_f32 v8, v8
  s_nop 0
  v_mul_f32 v168, v168, v8
  v_mul_f32 v169, v169, v8
  v_mul_f32 v170, v170, v8
  v_mul_f32 v171, v171, v8
  v_mul_f32 v172, v172, v8
  v_mul_f32 v173, v173, v8
  v_mul_f32 v174, v174, v8
  v_mul_f32 v175, v175, v8
  v_mul_f32 v176, v176, v8
  v_mul_f32 v177, v177, v8
  v_mul_f32 v178, v178, v8
  v_mul_f32 v179, v179, v8
  v_mul_f32 v180, v180, v8
  v_mul_f32 v181, v181, v8
  v_mul_f32 v182, v182, v8
  v_mul_f32 v183, v183, v8
  v_cndmask_b32 v180, 0, v180, vcc
  v_cndmask_b32 v181, 0, v181, vcc
  v_cndmask_b32 v182, 0, v182, vcc
  v_cndmask_b32 v183, 0, v183, vcc
  s_add_u32 s35, s91, 0
  v_cvt_pk_bf16_f32 v240, v168, v169
  v_cvt_pk_bf16_f32 v241, v170, v171
  v_cvt_pk_bf16_f32 v242, v172, v173
  v_cvt_pk_bf16_f32 v243, v174, v175
  buffer_store_dwordx4 v[240:243], v249, s[44:47], s35 offen offset:0 sc1
  v_cvt_pk_bf16_f32 v244, v176, v177
  v_cvt_pk_bf16_f32 v245, v178, v179
  v_cvt_pk_bf16_f32 v246, v180, v181
  v_cvt_pk_bf16_f32 v247, v182, v183
  buffer_store_dwordx4 v[244:247], v249, s[44:47], s35 offen offset:2048 sc1
  v_mov_b32 v7, v212
  v_mov_b32 v8, v212
  s_nop 1
  v_permlane32_swap_b32 v7, v8
  v_add_f32 v8, s71, v8
  v_rcp_f32 v8, v8
  s_nop 0
  v_mul_f32 v200, v200, v8
  v_mul_f32 v201, v201, v8
  v_mul_f32 v202, v202, v8
  v_mul_f32 v203, v203, v8
  v_mul_f32 v204, v204, v8
  v_mul_f32 v205, v205, v8
  v_mul_f32 v206, v206, v8
  v_mul_f32 v207, v207, v8
  v_mul_f32 v208, v208, v8
  v_mul_f32 v209, v209, v8
  v_mul_f32 v210, v210, v8
  v_mul_f32 v211, v211, v8
  v_mul_f32 v212, v212, v8
  v_mul_f32 v213, v213, v8
  v_mul_f32 v214, v214, v8
  v_mul_f32 v215, v215, v8
  v_cndmask_b32 v212, 0, v212, vcc
  v_cndmask_b32 v213, 0, v213, vcc
  v_cndmask_b32 v214, 0, v214, vcc
  v_cndmask_b32 v215, 0, v215, vcc
  s_add_u32 s35, s91, 4096
  v_cvt_pk_bf16_f32 v240, v200, v201
  v_cvt_pk_bf16_f32 v241, v202, v203
  v_cvt_pk_bf16_f32 v242, v204, v205
  v_cvt_pk_bf16_f32 v243, v206, v207
  buffer_store_dwordx4 v[240:243], v249, s[44:47], s35 offen offset:0 sc1
  v_cvt_pk_bf16_f32 v244, v208, v209
  v_cvt_pk_bf16_f32 v245, v210, v211
  v_cvt_pk_bf16_f32 v246, v212, v213
  v_cvt_pk_bf16_f32 v247, v214, v215
  buffer_store_dwordx4 v[244:247], v249, s[44:47], s35 offen offset:2048 sc1
Loi_48:
  v_mfma_f32_32x32x16_bf16 v[72:87], v[24:27], v[28:31], v[72:87]
  ds_read_b64_tr_b16 v[48:49], v14 offset:49152
  ds_read_b64_tr_b16 v[50:51], v14 offset:50176
  ds_read_b128 v[52:55], v11 offset:49152
  v_mfma_f32_32x32x16_bf16 v[88:103], v[24:27], v[32:35], v[88:103]
  ds_read_b128 v[56:59], v11 offset:49664
  ds_read_b64_tr_b16 v[60:61], v14 offset:51200
  ds_read_b64_tr_b16 v[62:63], v14 offset:52224
  v_mfma_f32_32x32x16_bf16 v[72:87], v[36:39], v[40:43], v[72:87]
  ds_read_b128 v[64:67], v11 offset:51200
  ds_read_b128 v[68:71], v11 offset:51712
  v_mfma_f32_32x32x16_bf16 v[88:103], v[36:39], v[44:47], v[88:103]
  s_waitcnt lgkmcnt(0)
  s_barrier
  v_mfma_f32_32x32x16_bf16 v[72:87], v[48:51], v[52:55], v[72:87]
  ds_read_b64_tr_b16 v[24:25], v15 offset:0
  ds_read_b64_tr_b16 v[26:27], v15 offset:1024
  ds_read_b128 v[28:31], v12 offset:0
  v_mfma_f32_32x32x16_bf16 v[88:103], v[48:51], v[56:59], v[88:103]
  ds_read_b128 v[32:35], v12 offset:512
  ds_read_b64_tr_b16 v[36:37], v15 offset:2048
  ds_read_b64_tr_b16 v[38:39], v15 offset:3072
  v_mfma_f32_32x32x16_bf16 v[72:87], v[60:63], v[64:67], v[72:87]
  ds_read_b128 v[40:43], v12 offset:2048
  ds_read_b128 v[44:47], v12 offset:2560
  v_mfma_f32_32x32x16_bf16 v[88:103], v[60:63], v[68:71], v[88:103]
  s_waitcnt lgkmcnt(0)
  s_barrier
  v_mfma_f32_32x32x16_bf16 v[72:87], v[24:27], v[28:31], v[72:87]
  ds_read_b64_tr_b16 v[48:49], v13 offset:0
  ds_read_b64_tr_b16 v[50:51], v13 offset:1024
  ds_read_b128 v[52:55], v10 offset:0
  v_mfma_f32_32x32x16_bf16 v[88:103], v[24:27], v[32:35], v[88:103]
  ds_read_b128 v[56:59], v10 offset:512
  ds_read_b64_tr_b16 v[60:61], v13 offset:2048
  ds_read_b64_tr_b16 v[62:63], v13 offset:3072
  v_mfma_f32_32x32x16_bf16 v[72:87], v[36:39], v[40:43], v[72:87]
  ds_read_b128 v[64:67], v10 offset:2048
  ds_read_b128 v[68:71], v10 offset:2560
  v_mfma_f32_32x32x16_bf16 v[88:103], v[36:39], v[44:47], v[88:103]
  s_waitcnt lgkmcnt(0)
  s_barrier
  v_mfma_f32_32x32x16_bf16 v[72:87], v[48:51], v[52:55], v[72:87]
  ds_read_b64_tr_b16 v[24:25], v13 offset:16384
  ds_read_b64_tr_b16 v[26:27], v13 offset:17408
  ds_read_b128 v[28:31], v10 offset:16384
  v_mfma_f32_32x32x16_bf16 v[88:103], v[48:51], v[56:59], v[88:103]
  ds_read_b128 v[32:35], v10 offset:16896
  ds_read_b64_tr_b16 v[36:37], v13 offset:18432
  ds_read_b64_tr_b16 v[38:39], v13 offset:19456
  v_mfma_f32_32x32x16_bf16 v[72:87], v[60:63], v[64:67], v[72:87]
  ds_read_b128 v[40:43], v10 offset:18432
  ds_read_b128 v[44:47], v10 offset:18944
  v_mfma_f32_32x32x16_bf16 v[88:103], v[60:63], v[68:71], v[88:103]
  s_waitcnt lgkmcnt(0)
  s_barrier
  v_mfma_f32_32x32x16_bf16 v[72:87], v[24:27], v[28:31], v[72:87]
  ds_read_b64_tr_b16 v[48:49], v13 offset:32768
  ds_read_b64_tr_b16 v[50:51], v13 offset:33792
  ds_read_b128 v[52:55], v10 offset:32768
  v_mfma_f32_32x32x16_bf16 v[88:103], v[24:27], v[32:35], v[88:103]
  ds_read_b128 v[56:59], v10 offset:33280
  ds_read_b64_tr_b16 v[60:61], v13 offset:34816
  ds_read_b64_tr_b16 v[62:63], v13 offset:35840
  v_mfma_f32_32x32x16_bf16 v[72:87], v[36:39], v[40:43], v[72:87]
  ds_read_b128 v[64:67], v10 offset:34816
  ds_read_b128 v[68:71], v10 offset:35328
  v_mfma_f32_32x32x16_bf16 v[88:103], v[36:39], v[44:47], v[88:103]
  s_waitcnt lgkmcnt(0)
  s_cmp_eq_u32 s75, 1
  s_cbranch_scc1 Lop_49
  s_waitcnt vmcnt(0)
Lop_49:
  s_barrier
  s_cmp_eq_u32 s75, 1
  s_cbranch_scc1 Loq_50
  s_cmp_lg_u32 s28, 0
  s_cbranch_scc1 Lpub_51
  v_mov_b32 v7, s74
  v_mov_b32 v8, 0
  s_mov_b64 exec, 1
  buffer_store_dword v7, v8, s[44:47], s82 offen sc1
  s_mov_b64 exec, -1
Lpub_51:
Loq_50:
  v_mfma_f32_32x32x16_bf16 v[72:87], v[48:51], v[52:55], v[72:87]
  ds_read_b64_tr_b16 v[24:25], v13 offset:49152
  ds_read_b64_tr_b16 v[26:27], v13 offset:50176
  ds_read_b128 v[28:31], v10 offset:49152
  v_mfma_f32_32x32x16_bf16 v[88:103], v[48:51], v[56:59], v[88:103]
  ds_read_b128 v[32:35], v10 offset:49664
  ds_read_b64_tr_b16 v[36:37], v13 offset:51200
  ds_read_b64_tr_b16 v[38:39], v13 offset:52224
  v_mfma_f32_32x32x16_bf16 v[72:87], v[60:63], v[64:67], v[72:87]
  ds_read_b128 v[40:43], v10 offset:51200
  ds_read_b128 v[44:47], v10 offset:51712
  v_mfma_f32_32x32x16_bf16 v[88:103], v[60:63], v[68:71], v[88:103]
  s_waitcnt lgkmcnt(0)
  s_barrier
  v_mfma_f32_32x32x16_bf16 v[72:87], v[24:27], v[28:31], v[72:87]
  ds_read_b64_tr_b16 v[48:49], v14 offset:0
  ds_read_b64_tr_b16 v[50:51], v14 offset:1024
  ds_read_b128 v[52:55], v11 offset:0
  v_mfma_f32_32x32x16_bf16 v[88:103], v[24:27], v[32:35], v[88:103]
  ds_read_b128 v[56:59], v11 offset:512
  ds_read_b64_tr_b16 v[60:61], v14 offset:2048
  ds_read_b64_tr_b16 v[62:63], v14 offset:3072
  v_mfma_f32_32x32x16_bf16 v[72:87], v[36:39], v[40:43], v[72:87]
  ds_read_b128 v[64:67], v11 offset:2048
  ds_read_b128 v[68:71], v11 offset:2560
  v_mfma_f32_32x32x16_bf16 v[88:103], v[36:39], v[44:47], v[88:103]
  s_waitcnt lgkmcnt(0)
  s_barrier
  v_mfma_f32_32x32x16_bf16 v[72:87], v[48:51], v[52:55], v[72:87]
  ds_read_b64_tr_b16 v[24:25], v14 offset:16384
  ds_read_b64_tr_b16 v[26:27], v14 offset:17408
  ds_read_b128 v[28:31], v11 offset:16384
  v_mfma_f32_32x32x16_bf16 v[88:103], v[48:51], v[56:59], v[88:103]
  ds_read_b128 v[32:35], v11 offset:16896
  ds_read_b64_tr_b16 v[36:37], v14 offset:18432
  ds_read_b64_tr_b16 v[38:39], v14 offset:19456
  v_mfma_f32_32x32x16_bf16 v[72:87], v[60:63], v[64:67], v[72:87]
  ds_read_b128 v[40:43], v11 offset:18432
  ds_read_b128 v[44:47], v11 offset:18944
  v_mfma_f32_32x32x16_bf16 v[88:103], v[60:63], v[68:71], v[88:103]
  s_waitcnt lgkmcnt(0)
  s_barrier
  v_mfma_f32_32x32x16_bf16 v[72:87], v[24:27], v[28:31], v[72:87]
  ds_read_b64_tr_b16 v[48:49], v14 offset:32768
  ds_read_b64_tr_b16 v[50:51], v14 offset:33792
  ds_read_b128 v[52:55], v11 offset:32768
  v_mfma_f32_32x32x16_bf16 v[88:103], v[24:27], v[32:35], v[88:103]
  ds_read_b128 v[56:59], v11 offset:33280
  ds_read_b64_tr_b16 v[60:61], v14 offset:34816
  ds_read_b64_tr_b16 v[62:63], v14 offset:35840
  v_mfma_f32_32x32x16_bf16 v[72:87], v[36:39], v[40:43], v[72:87]
  ds_read_b128 v[64:67], v11 offset:34816
  ds_read_b128 v[68:71], v11 offset:35328
  v_mfma_f32_32x32x16_bf16 v[88:103], v[36:39], v[44:47], v[88:103]
  s_waitcnt lgkmcnt(0)
  s_barrier
  v_mfma_f32_32x32x16_bf16 v[72:87], v[48:51], v[52:55], v[72:87]
  ds_read_b64_tr_b16 v[24:25], v14 offset:49152
  ds_read_b64_tr_b16 v[26:27], v14 offset:50176
  ds_read_b128 v[28:31], v11 offset:49152
  v_mfma_f32_32x32x16_bf16 v[88:103], v[48:51], v[56:59], v[88:103]
  ds_read_b128 v[32:35], v11 offset:49664
  ds_read_b64_tr_b16 v[36:37], v14 offset:51200
  ds_read_b64_tr_b16 v[38:39], v14 offset:52224
  v_mfma_f32_32x32x16_bf16 v[72:87], v[60:63], v[64:67], v[72:87]
  ds_read_b128 v[40:43], v11 offset:51200
  ds_read_b128 v[44:47], v11 offset:51712
  v_mfma_f32_32x32x16_bf16 v[88:103], v[60:63], v[68:71], v[88:103]
  s_waitcnt lgkmcnt(0)
  s_barrier
  v_mfma_f32_32x32x16_bf16 v[72:87], v[24:27], v[28:31], v[72:87]
  ds_read_b64_tr_b16 v[48:49], v15 offset:0
  ds_read_b64_tr_b16 v[50:51], v15 offset:1024
  ds_read_b128 v[52:55], v12 offset:0
  v_mfma_f32_32x32x16_bf16 v[88:103], v[24:27], v[32:35], v[88:103]
  ds_read_b128 v[56:59], v12 offset:512
  ds_read_b64_tr_b16 v[60:61], v15 offset:2048
  ds_read_b64_tr_b16 v[62:63], v15 offset:3072
  v_mfma_f32_32x32x16_bf16 v[72:87], v[36:39], v[40:43], v[72:87]
  ds_read_b128 v[64:67], v12 offset:2048
  ds_read_b128 v[68:71], v12 offset:2560
  v_mfma_f32_32x32x16_bf16 v[88:103], v[36:39], v[44:47], v[88:103]
  s_waitcnt lgkmcnt(0)
  s_barrier
  v_mfma_f32_32x32x16_bf16 v[72:87], v[48:51], v[52:55], v[72:87]
  ds_read_b64_tr_b16 v[24:25], v13 offset:0
  ds_read_b64_tr_b16 v[26:27], v13 offset:1024
  ds_read_b128 v[28:31], v10 offset:0
  v_mfma_f32_32x32x16_bf16 v[88:103], v[48:51], v[56:59], v[88:103]
  ds_read_b128 v[32:35], v10 offset:512
  ds_read_b64_tr_b16 v[36:37], v13 offset:2048
  ds_read_b64_tr_b16 v[38:39], v13 offset:3072
  v_mfma_f32_32x32x16_bf16 v[72:87], v[60:63], v[64:67], v[72:87]
  ds_read_b128 v[40:43], v10 offset:2048
  ds_read_b128 v[44:47], v10 offset:2560
  v_mfma_f32_32x32x16_bf16 v[88:103], v[60:63], v[68:71], v[88:103]
  s_waitcnt lgkmcnt(0)
  s_barrier
  v_mfma_f32_32x32x16_bf16 v[72:87], v[24:27], v[28:31], v[72:87]
  ds_read_b64_tr_b16 v[48:49], v13 offset:16384
  ds_read_b64_tr_b16 v[50:51], v13 offset:17408
  ds_read_b128 v[52:55], v10 offset:16384
  v_mfma_f32_32x32x16_bf16 v[88:103], v[24:27], v[32:35], v[88:103]
  ds_read_b128 v[56:59], v10 offset:16896
  ds_read_b64_tr_b16 v[60:61], v13 offset:18432
  ds_read_b64_tr_b16 v[62:63], v13 offset:19456
  v_mfma_f32_32x32x16_bf16 v[72:87], v[36:39], v[40:43], v[72:87]
  ds_read_b128 v[64:67], v10 offset:18432
  ds_read_b128 v[68:71], v10 offset:18944
  v_mfma_f32_32x32x16_bf16 v[88:103], v[36:39], v[44:47], v[88:103]
  s_waitcnt lgkmcnt(0)
  s_barrier
  v_mfma_f32_32x32x16_bf16 v[72:87], v[48:51], v[52:55], v[72:87]
  ds_read_b64_tr_b16 v[24:25], v13 offset:32768
  ds_read_b64_tr_b16 v[26:27], v13 offset:33792
  ds_read_b128 v[28:31], v10 offset:32768
  v_mfma_f32_32x32x16_bf16 v[88:103], v[48:51], v[56:59], v[88:103]
  ds_read_b128 v[32:35], v10 offset:33280
  ds_read_b64_tr_b16 v[36:37], v13 offset:34816
  ds_read_b64_tr_b16 v[38:39], v13 offset:35840
  v_mfma_f32_32x32x16_bf16 v[72:87], v[60:63], v[64:67], v[72:87]
  ds_read_b128 v[40:43], v10 offset:34816
  ds_read_b128 v[44:47], v10 offset:35328
  v_mfma_f32_32x32x16_bf16 v[88:103], v[60:63], v[68:71], v[88:103]
  s_waitcnt lgkmcnt(0)
  s_barrier
  v_mfma_f32_32x32x16_bf16 v[72:87], v[24:27], v[28:31], v[72:87]
  ds_read_b64_tr_b16 v[48:49], v13 offset:49152
  ds_read_b64_tr_b16 v[50:51], v13 offset:50176
  ds_read_b128 v[52:55], v10 offset:49152
  v_mfma_f32_32x32x16_bf16 v[88:103], v[24:27], v[32:35], v[88:103]
  ds_read_b128 v[56:59], v10 offset:49664
  ds_read_b64_tr_b16 v[60:61], v13 offset:51200
  ds_read_b64_tr_b16 v[62:63], v13 offset:52224
  v_mfma_f32_32x32x16_bf16 v[72:87], v[36:39], v[40:43], v[72:87]
  ds_read_b128 v[64:67], v10 offset:51200
  ds_read_b128 v[68:71], v10 offset:51712
  v_mfma_f32_32x32x16_bf16 v[88:103], v[36:39], v[44:47], v[88:103]
  s_waitcnt lgkmcnt(0)
  s_barrier
  v_mfma_f32_32x32x16_bf16 v[72:87], v[48:51], v[52:55], v[72:87]
  ds_read_b64_tr_b16 v[24:25], v14 offset:0
  ds_read_b64_tr_b16 v[26:27], v14 offset:1024
  ds_read_b128 v[28:31], v11 offset:0
  v_mfma_f32_32x32x16_bf16 v[88:103], v[48:51], v[56:59], v[88:103]
  ds_read_b128 v[32:35], v11 offset:512
  ds_read_b64_tr_b16 v[36:37], v14 offset:2048
  ds_read_b64_tr_b16 v[38:39], v14 offset:3072
  v_mfma_f32_32x32x16_bf16 v[72:87], v[60:63], v[64:67], v[72:87]
  ds_read_b128 v[40:43], v11 offset:2048
  ds_read_b128 v[44:47], v11 offset:2560
  v_mfma_f32_32x32x16_bf16 v[88:103], v[60:63], v[68:71], v[88:103]
  s_waitcnt lgkmcnt(0)
  s_barrier
  v_mfma_f32_32x32x16_bf16 v[72:87], v[24:27], v[28:31], v[72:87]
  ds_read_b64_tr_b16 v[48:49], v14 offset:16384
  ds_read_b64_tr_b16 v[50:51], v14 offset:17408
  ds_read_b128 v[52:55], v11 offset:16384
  v_mfma_f32_32x32x16_bf16 v[88:103], v[24:27], v[32:35], v[88:103]
  ds_read_b128 v[56:59], v11 offset:16896
  ds_read_b64_tr_b16 v[60:61], v14 offset:18432
  ds_read_b64_tr_b16 v[62:63], v14 offset:19456
  v_mfma_f32_32x32x16_bf16 v[72:87], v[36:39], v[40:43], v[72:87]
  ds_read_b128 v[64:67], v11 offset:18432
  ds_read_b128 v[68:71], v11 offset:18944
  v_mfma_f32_32x32x16_bf16 v[88:103], v[36:39], v[44:47], v[88:103]
  s_waitcnt lgkmcnt(0)
  s_barrier
  v_mfma_f32_32x32x16_bf16 v[72:87], v[48:51], v[52:55], v[72:87]
  ds_read_b64_tr_b16 v[24:25], v14 offset:32768
  ds_read_b64_tr_b16 v[26:27], v14 offset:33792
  ds_read_b128 v[28:31], v11 offset:32768
  v_mfma_f32_32x32x16_bf16 v[88:103], v[48:51], v[56:59], v[88:103]
  ds_read_b128 v[32:35], v11 offset:33280
  ds_read_b64_tr_b16 v[36:37], v14 offset:34816
  ds_read_b64_tr_b16 v[38:39], v14 offset:35840
  v_mfma_f32_32x32x16_bf16 v[72:87], v[60:63], v[64:67], v[72:87]
  ds_read_b128 v[40:43], v11 offset:34816
  ds_read_b128 v[44:47], v11 offset:35328
  v_mfma_f32_32x32x16_bf16 v[88:103], v[60:63], v[68:71], v[88:103]
  s_waitcnt lgkmcnt(0)
  s_barrier
  v_mfma_f32_32x32x16_bf16 v[72:87], v[24:27], v[28:31], v[72:87]
  ds_read_b64_tr_b16 v[48:49], v14 offset:49152
  ds_read_b64_tr_b16 v[50:51], v14 offset:50176
  ds_read_b128 v[52:55], v11 offset:49152
  v_mfma_f32_32x32x16_bf16 v[88:103], v[24:27], v[32:35], v[88:103]
  ds_read_b128 v[56:59], v11 offset:49664
  ds_read_b64_tr_b16 v[60:61], v14 offset:51200
  ds_read_b64_tr_b16 v[62:63], v14 offset:52224
  v_mfma_f32_32x32x16_bf16 v[72:87], v[36:39], v[40:43], v[72:87]
  ds_read_b128 v[64:67], v11 offset:51200
  ds_read_b128 v[68:71], v11 offset:51712
  v_mfma_f32_32x32x16_bf16 v[88:103], v[36:39], v[44:47], v[88:103]
  s_waitcnt lgkmcnt(0)
  s_barrier
  v_mfma_f32_32x32x16_bf16 v[72:87], v[48:51], v[52:55], v[72:87]
  ds_read_b64_tr_b16 v[24:25], v15 offset:0
  ds_read_b64_tr_b16 v[26:27], v15 offset:1024
  ds_read_b128 v[28:31], v12 offset:0
  v_mfma_f32_32x32x16_bf16 v[88:103], v[48:51], v[56:59], v[88:103]
  ds_read_b128 v[32:35], v12 offset:512
  ds_read_b64_tr_b16 v[36:37], v15 offset:2048
  ds_read_b64_tr_b16 v[38:39], v15 offset:3072
  v_mfma_f32_32x32x16_bf16 v[72:87], v[60:63], v[64:67], v[72:87]
  ds_read_b128 v[40:43], v12 offset:2048
  ds_read_b128 v[44:47], v12 offset:2560
  v_mfma_f32_32x32x16_bf16 v[88:103], v[60:63], v[68:71], v[88:103]
  s_waitcnt lgkmcnt(0)
  s_barrier
  v_mfma_f32_32x32x16_bf16 v[72:87], v[24:27], v[28:31], v[72:87]
  ds_read_b64_tr_b16 v[48:49], v13 offset:0
  ds_read_b64_tr_b16 v[50:51], v13 offset:1024
  ds_read_b128 v[52:55], v10 offset:0
  v_mfma_f32_32x32x16_bf16 v[88:103], v[24:27], v[32:35], v[88:103]
  ds_read_b128 v[56:59], v10 offset:512
  ds_read_b64_tr_b16 v[60:61], v13 offset:2048
  ds_read_b64_tr_b16 v[62:63], v13 offset:3072
  v_mfma_f32_32x32x16_bf16 v[72:87], v[36:39], v[40:43], v[72:87]
  ds_read_b128 v[64:67], v10 offset:2048
  ds_read_b128 v[68:71], v10 offset:2560
  v_mfma_f32_32x32x16_bf16 v[88:103], v[36:39], v[44:47], v[88:103]
  s_waitcnt lgkmcnt(0)
  s_barrier
  s_lshl_b32 s62, s72, 8
  s_add_u32 s62, s62, 16384
  buffer_load_dword v104, v19, s[44:47], s62 offen offset:0 sc1
  buffer_load_dword v105, v19, s[44:47], s62 offen offset:128 sc1
  s_lshl_b32 s35, s60, 9
  v_subrev_u32 v13, s35, v13
  v_subrev_u32 v14, s35, v14
  v_subrev_u32 v15, s35, v15
  v_mfma_f32_32x32x16_bf16 v[72:87], v[48:51], v[52:55], v[72:87]
  ds_read_b64_tr_b16 v[24:25], v13 offset:16384
  ds_read_b64_tr_b16 v[26:27], v13 offset:17408
  ds_read_b128 v[28:31], v10 offset:16384
  v_mfma_f32_32x32x16_bf16 v[88:103], v[48:51], v[56:59], v[88:103]
  ds_read_b128 v[32:35], v10 offset:16896
  ds_read_b64_tr_b16 v[36:37], v13 offset:18432
  ds_read_b64_tr_b16 v[38:39], v13 offset:19456
  v_mfma_f32_32x32x16_bf16 v[72:87], v[60:63], v[64:67], v[72:87]
  ds_read_b128 v[40:43], v10 offset:18432
  ds_read_b128 v[44:47], v10 offset:18944
  v_mfma_f32_32x32x16_bf16 v[88:103], v[60:63], v[68:71], v[88:103]
  s_waitcnt lgkmcnt(0)
  s_barrier
  v_mfma_f32_32x32x16_bf16 v[136:151], v[24:27], v[28:31], 0
  ds_read_b64_tr_b16 v[48:49], v13 offset:32768
  ds_read_b64_tr_b16 v[50:51], v13 offset:33792
  ds_read_b128 v[52:55], v10 offset:32768
  v_mfma_f32_32x32x16_bf16 v[152:167], v[24:27], v[32:35], 0
  ds_read_b128 v[56:59], v10 offset:33280
  ds_read_b64_tr_b16 v[60:61], v13 offset:34816
  ds_read_b64_tr_b16 v[62:63], v13 offset:35840
  v_mfma_f32_32x32x16_bf16 v[136:151], v[36:39], v[40:43], v[136:151]
  ds_read_b128 v[64:67], v10 offset:34816
  ds_read_b128 v[68:71], v10 offset:35328
  v_mfma_f32_32x32x16_bf16 v[152:167], v[36:39], v[44:47], v[152:167]
  s_waitcnt lgkmcnt(0)
  s_barrier
  v_mfma_f32_32x32x16_bf16 v[136:151], v[48:51], v[52:55], v[136:151]
  ds_read_b64_tr_b16 v[24:25], v13 offset:49152
  ds_read_b64_tr_b16 v[26:27], v13 offset:50176
  ds_read_b128 v[28:31], v10 offset:49152
  v_mfma_f32_32x32x16_bf16 v[152:167], v[48:51], v[56:59], v[152:167]
  ds_read_b128 v[32:35], v10 offset:49664
  ds_read_b64_tr_b16 v[36:37], v13 offset:51200
  ds_read_b64_tr_b16 v[38:39], v13 offset:52224
  v_mfma_f32_32x32x16_bf16 v[136:151], v[60:63], v[64:67], v[136:151]
  ds_read_b128 v[40:43], v10 offset:51200
  ds_read_b128 v[44:47], v10 offset:51712
  v_mfma_f32_32x32x16_bf16 v[152:167], v[60:63], v[68:71], v[152:167]
  s_waitcnt vmcnt(0)
  v_sub_f32 v106, 1.0, v104
  v_sub_f32 v107, 1.0, v105
  v_mul_f32 v72, v72, v106
  v_mul_f32 v73, v73, v106
  v_mul_f32 v74, v74, v106
  v_mul_f32 v75, v75, v106
  v_mul_f32 v76, v76, v106
  v_mul_f32 v77, v77, v106
  v_mul_f32 v78, v78, v106
  v_mul_f32 v79, v79, v106
  v_mul_f32 v80, v80, v106
  v_mul_f32 v81, v81, v106
  v_mul_f32 v82, v82, v106
  v_mul_f32 v83, v83, v106
  v_mul_f32 v84, v84, v106
  v_mul_f32 v85, v85, v106
  v_mul_f32 v86, v86, v106
  v_mul_f32 v87, v87, v106
  v_mul_f32 v88, v88, v107
  v_mul_f32 v89, v89, v107
  v_mul_f32 v90, v90, v107
  v_mul_f32 v91, v91, v107
  v_mul_f32 v92, v92, v107
  v_mul_f32 v93, v93, v107
  v_mul_f32 v94, v94, v107
  v_mul_f32 v95, v95, v107
  v_mul_f32 v96, v96, v107
  v_mul_f32 v97, v97, v107
  v_mul_f32 v98, v98, v107
  v_mul_f32 v99, v99, v107
  v_mul_f32 v100, v100, v107
  v_mul_f32 v101, v101, v107
  v_mul_f32 v102, v102, v107
  v_mul_f32 v103, v103, v107
  s_waitcnt lgkmcnt(0)
  s_barrier
  v_mfma_f32_32x32x16_bf16 v[136:151], v[24:27], v[28:31], v[136:151]
  ds_read_b64_tr_b16 v[48:49], v14 offset:0
  ds_read_b64_tr_b16 v[50:51], v14 offset:1024
  ds_read_b128 v[52:55], v11 offset:0
  v_mfma_f32_32x32x16_bf16 v[152:167], v[24:27], v[32:35], v[152:167]
  ds_read_b128 v[56:59], v11 offset:512
  ds_read_b64_tr_b16 v[60:61], v14 offset:2048
  ds_read_b64_tr_b16 v[62:63], v14 offset:3072
  v_mfma_f32_32x32x16_bf16 v[136:151], v[36:39], v[40:43], v[136:151]
  ds_read_b128 v[64:67], v11 offset:2048
  ds_read_b128 v[68:71], v11 offset:2560
  v_mfma_f32_32x32x16_bf16 v[152:167], v[36:39], v[44:47], v[152:167]
  s_waitcnt lgkmcnt(0)
  s_barrier
  v_mfma_f32_32x32x16_bf16 v[136:151], v[48:51], v[52:55], v[136:151]
  ds_read_b64_tr_b16 v[24:25], v14 offset:16384
  ds_read_b64_tr_b16 v[26:27], v14 offset:17408
  ds_read_b128 v[28:31], v11 offset:16384
  v_mfma_f32_32x32x16_bf16 v[152:167], v[48:51], v[56:59], v[152:167]
  ds_read_b128 v[32:35], v11 offset:16896
  ds_read_b64_tr_b16 v[36:37], v14 offset:18432
  ds_read_b64_tr_b16 v[38:39], v14 offset:19456
  v_mfma_f32_32x32x16_bf16 v[136:151], v[60:63], v[64:67], v[136:151]
  ds_read_b128 v[40:43], v11 offset:18432
  ds_read_b128 v[44:47], v11 offset:18944
  v_mfma_f32_32x32x16_bf16 v[152:167], v[60:63], v[68:71], v[152:167]
  s_waitcnt lgkmcnt(0)
  s_barrier
  v_mfma_f32_32x32x16_bf16 v[136:151], v[24:27], v[28:31], v[136:151]
  ds_read_b64_tr_b16 v[48:49], v14 offset:32768
  ds_read_b64_tr_b16 v[50:51], v14 offset:33792
  ds_read_b128 v[52:55], v11 offset:32768
  v_mfma_f32_32x32x16_bf16 v[152:167], v[24:27], v[32:35], v[152:167]
  ds_read_b128 v[56:59], v11 offset:33280
  ds_read_b64_tr_b16 v[60:61], v14 offset:34816
  ds_read_b64_tr_b16 v[62:63], v14 offset:35840
  v_mfma_f32_32x32x16_bf16 v[136:151], v[36:39], v[40:43], v[136:151]
  ds_read_b128 v[64:67], v11 offset:34816
  ds_read_b128 v[68:71], v11 offset:35328
  v_mfma_f32_32x32x16_bf16 v[152:167], v[36:39], v[44:47], v[152:167]
  s_waitcnt lgkmcnt(0)
  s_barrier
  v_mfma_f32_32x32x16_bf16 v[136:151], v[48:51], v[52:55], v[136:151]
  ds_read_b64_tr_b16 v[24:25], v14 offset:49152
  ds_read_b64_tr_b16 v[26:27], v14 offset:50176
  ds_read_b128 v[28:31], v11 offset:49152
  v_mfma_f32_32x32x16_bf16 v[152:167], v[48:51], v[56:59], v[152:167]
  ds_read_b128 v[32:35], v11 offset:49664
  ds_read_b64_tr_b16 v[36:37], v14 offset:51200
  ds_read_b64_tr_b16 v[38:39], v14 offset:52224
  v_mfma_f32_32x32x16_bf16 v[136:151], v[60:63], v[64:67], v[136:151]
  ds_read_b128 v[40:43], v11 offset:51200
  ds_read_b128 v[44:47], v11 offset:51712
  v_mfma_f32_32x32x16_bf16 v[152:167], v[60:63], v[68:71], v[152:167]
  s_waitcnt lgkmcnt(0)
  s_barrier
  v_mfma_f32_32x32x16_bf16 v[136:151], v[24:27], v[28:31], v[136:151]
  ds_read_b64_tr_b16 v[48:49], v15 offset:0
  ds_read_b64_tr_b16 v[50:51], v15 offset:1024
  ds_read_b128 v[52:55], v12 offset:0
  v_mfma_f32_32x32x16_bf16 v[152:167], v[24:27], v[32:35], v[152:167]
  ds_read_b128 v[56:59], v12 offset:512
  ds_read_b64_tr_b16 v[60:61], v15 offset:2048
  ds_read_b64_tr_b16 v[62:63], v15 offset:3072
  v_mfma_f32_32x32x16_bf16 v[136:151], v[36:39], v[40:43], v[136:151]
  ds_read_b128 v[64:67], v12 offset:2048
  ds_read_b128 v[68:71], v12 offset:2560
  v_mfma_f32_32x32x16_bf16 v[152:167], v[36:39], v[44:47], v[152:167]
  s_waitcnt lgkmcnt(0)
  s_barrier
  v_mfma_f32_32x32x16_bf16 v[136:151], v[48:51], v[52:55], v[136:151]
  v_mfma_f32_32x32x16_bf16 v[152:167], v[48:51], v[56:59], v[152:167]
  v_mfma_f32_32x32x16_bf16 v[136:151], v[60:63], v[64:67], v[136:151]
  v_mfma_f32_32x32x16_bf16 v[152:167], v[60:63], v[68:71], v[152:167]
  s_nop 7
  s_nop 3
  v_fmac_f32 v72, v136, v104
  v_fmac_f32 v73, v137, v104
  v_fmac_f32 v74, v138, v104
  v_fmac_f32 v75, v139, v104
  v_fmac_f32 v76, v140, v104
  v_fmac_f32 v77, v141, v104
  v_fmac_f32 v78, v142, v104
  v_fmac_f32 v79, v143, v104
  v_fmac_f32 v80, v144, v104
  v_fmac_f32 v81, v145, v104
  v_fmac_f32 v82, v146, v104
  v_fmac_f32 v83, v147, v104
  v_fmac_f32 v84, v148, v104
  v_fmac_f32 v85, v149, v104
  v_fmac_f32 v86, v150, v104
  v_fmac_f32 v87, v151, v104
  v_fmac_f32 v88, v152, v105
  v_fmac_f32 v89, v153, v105
  v_fmac_f32 v90, v154, v105
  v_fmac_f32 v91, v155, v105
  v_fmac_f32 v92, v156, v105
  v_fmac_f32 v93, v157, v105
  v_fmac_f32 v94, v158, v105
  v_fmac_f32 v95, v159, v105
  v_fmac_f32 v96, v160, v105
  v_fmac_f32 v97, v161, v105
  v_fmac_f32 v98, v162, v105
  v_fmac_f32 v99, v163, v105
  v_fmac_f32 v100, v164, v105
  v_fmac_f32 v101, v165, v105
  v_fmac_f32 v102, v166, v105
  v_fmac_f32 v103, v167, v105
  s_lshl_b32 s35, s29, 12
  v_add_u32 v7, s35, v18
  s_xor_b32 s35, s29, 2
  s_lshl_b32 s35, s35, 12
  v_add_u32 v8, s35, v18
  s_cmp_eq_u32 s60, 0
  s_cbranch_scc1 Lr_52
  ds_write_b128 v7, v[72:75] offset:0
  ds_write_b128 v7, v[76:79] offset:1024
  ds_write_b128 v7, v[80:83] offset:2048
  ds_write_b128 v7, v[84:87] offset:3072
  s_nop 1
  v_mov_b32 v72, v88
  v_mov_b32 v73, v89
  v_mov_b32 v74, v90
  v_mov_b32 v75, v91
  v_mov_b32 v76, v92
  v_mov_b32 v77, v93
  v_mov_b32 v78, v94
  v_mov_b32 v79, v95
  v_mov_b32 v80, v96
  v_mov_b32 v81, v97
  v_mov_b32 v82, v98
  v_mov_b32 v83, v99
  v_mov_b32 v84, v100
  v_mov_b32 v85, v101
  v_mov_b32 v86, v102
  v_mov_b32 v87, v103
  s_branch Lr_53
Lr_52:
  s_nop 1
  ds_write_b128 v7, v[88:91] offset:0
  ds_write_b128 v7, v[92:95] offset:1024
  ds_write_b128 v7, v[96:99] offset:2048
  ds_write_b128 v7, v[100:103] offset:3072
Lr_53:
  s_waitcnt lgkmcnt(0)
  s_barrier
  ds_read_b128 v[88:91], v8 offset:0
  ds_read_b128 v[92:95], v8 offset:1024
  ds_read_b128 v[96:99], v8 offset:2048
  ds_read_b128 v[100:103], v8 offset:3072
  s_waitcnt lgkmcnt(0)
  v_add_f32 v72, v72, v88
  v_add_f32 v73, v73, v89
  v_add_f32 v74, v74, v90
  v_add_f32 v75, v75, v91
  v_add_f32 v76, v76, v92
  v_add_f32 v77, v77, v93
  v_add_f32 v78, v78, v94
  v_add_f32 v79, v79, v95
  v_add_f32 v80, v80, v96
  v_add_f32 v81, v81, v97
  v_add_f32 v82, v82, v98
  v_add_f32 v83, v83, v99
  v_add_f32 v84, v84, v100
  v_add_f32 v85, v85, v101
  v_add_f32 v86, v86, v102
  v_add_f32 v87, v87, v103
  v_cvt_pk_bf16_f32 v128, v72, v73
  v_cvt_pk_bf16_f32 v129, v74, v75
  v_cvt_pk_bf16_f32 v130, v76, v77
  v_cvt_pk_bf16_f32 v131, v78, v79
  v_cvt_pk_bf16_f32 v132, v80, v81
  v_cvt_pk_bf16_f32 v133, v82, v83
  v_cvt_pk_bf16_f32 v134, v84, v85
  v_cvt_pk_bf16_f32 v135, v86, v87
  s_nop 1
  v_permlane32_swap_b32 v128, v130
  v_permlane32_swap_b32 v129, v131
  v_permlane32_swap_b32 v132, v134
  v_permlane32_swap_b32 v133, v135
  v_mul_u32_u24 v7, 896, v2
  v_lshl_add_u32 v7, v3, 4, v7
  s_lshl_b32 s62, s72, 1
  s_add_u32 s62, s62, s60
  s_mul_i32 s62, s62, 28672
  s_lshl_b32 s35, s73, 7
  s_add_u32 s62, s62, s35
  s_lshl_b32 s35, s61, 6
  s_add_u32 s62, s62, s35
  buffer_store_dwordx4 v[128:131], v7, s[56:59], s62 offen offset:0
  buffer_store_dwordx4 v[132:135], v7, s[56:59], s62 offen offset:32
  s_endpgm
L_end:
  s_endpgm

.section .rodata,"a"
.p2align 6
.amdhsa_kernel gated_mix__linear_attn_block__dense_activation_squared_relu__prompt_kernel
  .amdhsa_next_free_vgpr 256
  .amdhsa_next_free_sgpr 102
  .amdhsa_accum_offset 256
  .amdhsa_group_segment_fixed_size 0
  .amdhsa_kernarg_size 96
  .amdhsa_user_sgpr_count 2
  .amdhsa_user_sgpr_kernarg_segment_ptr 1
  .amdhsa_system_sgpr_workgroup_id_x 1
  .amdhsa_float_denorm_mode_32 3
.end_amdhsa_kernel
```
